```python
import torch

def _softmax(x, axis=-1):
    return torch.softmax(x, dim=axis)
def _gelu(x):
    return torch.nn.functional.gelu(x, approximate="tanh")
def _silu(x):
    return torch.nn.functional.silu(x)
def _sigmoid(x):
    return torch.sigmoid(x)
def _layernorm(x, axis=-1, eps=1e-5):
    m = x.mean(dim=axis, keepdim=True)
    v = x.var(dim=axis, keepdim=True, unbiased=False)
    return (x - m) / torch.sqrt(v + eps)
def _scatter_add(tgt, idx, src, axis=0):
    return tgt.clone().index_add_(axis, idx, src)
def _segment_sum(src, seg, n):
    out = torch.zeros((n,) + src.shape[1:], dtype=src.dtype)
    return out.index_add_(0, seg, src)
def _pad(x, pw):
    flat = tuple(v for pair in reversed(pw) for v in pair)
    return torch.nn.functional.pad(x, flat)

kernel_name = 'interleave_layers__sliding_block_cached__glu_gated_swiglu__decode'

def setup_inputs():

    _w = (lambda a: (lambda t: t.to(torch.bfloat16) if t.is_floating_point() else t)(torch.as_tensor(a)))
    def _A_setup():
        B, Sq, D = 1, 1, 512
        Hq, Hkv, Sk, Dh = 32, 8, 65536, 128
        assert Hq % Hkv == 0, (Hq, Hkv)
        return {
            "x": _w((lambda *s: torch.randn(*s, dtype=torch.bfloat16) * 0.05)(B, Sq, D)),
            "k_cache": _w((lambda *s: torch.randn(*s, dtype=torch.bfloat16) * 0.8)(B, Hkv, Sk, Dh)),
            "v_cache": _w((lambda *s: torch.randn(*s, dtype=torch.bfloat16) * 0.8)(B, Hkv, Sk, Dh)),
            "wq": _w((lambda *s: torch.randn(*s, dtype=torch.bfloat16) * 0.8)(D, Hq * Dh) * (D ** -0.5)),
            "wo": _w((lambda *s: torch.randn(*s, dtype=torch.bfloat16) * 0.8)(Hq * Dh, D) * ((Hq * Dh) ** -0.5)),
        }
    _A_in = _A_setup()

    def _B_setup():
        B, S, D, F = 1, 1, 512, 1792
        return {
            "x": _w((lambda *s: torch.randn(*s, dtype=torch.bfloat16) * 0.05)(B, S, D)),
            "w1": _w((lambda *s: torch.randn(*s, dtype=torch.bfloat16) * 0.2)(D, F) * (2.0 / D) ** 0.5),
            "w3": _w((lambda *s: torch.randn(*s, dtype=torch.bfloat16) * 0.2)(D, F) * (2.0 / D) ** 0.5),
            "w2": _w((lambda *s: torch.randn(*s, dtype=torch.bfloat16) * 0.2)(F, D) * (2.0 / F) ** 0.5),
        }
    _B_in = _B_setup()

    return {
        "A_x": _A_in["x"],
        "A_k_cache": _A_in["k_cache"],
        "A_v_cache": _A_in["v_cache"],
        "A_wq": _A_in["wq"],
        "A_wo": _A_in["wo"],
        "B_x": _B_in["x"],
        "B_w1": _B_in["w1"],
        "B_w3": _B_in["w3"],
        "B_w2": _B_in["w2"],
    }

def reference(A_x, A_k_cache, A_v_cache, A_wq, A_wo, B_x, B_w1, B_w3, B_w2):
    def _A_ref(x, k_cache, v_cache, wq, wo):
        B, Sq, D = x.shape
        Hq, Dh = 32, 128
        Hkv, Sk = k_cache.shape[1], k_cache.shape[2]
        W = min(4096, max(256, Sk // 4))
        rep = Hq // Hkv
        q = (lambda x, *d: x.permute(*d))((x @ wq).reshape(B, Sq, Hq, Dh), 0, 2, 1, 3)
        k = (lambda x, n, axis: torch.repeat_interleave(x, n, dim=axis))(k_cache[:, :, Sk - W:, :], rep, axis=1)
        v = (lambda x, n, axis: torch.repeat_interleave(x, n, dim=axis))(v_cache[:, :, Sk - W:, :], rep, axis=1)
        scores = torch.einsum("bhqd,bhkd->bhqk", q, k) * (Dh ** -0.5)
        p = _softmax(scores, axis=-1)
        o = torch.einsum("bhqk,bhkd->bhqd", p, v)
        return (lambda x, *d: x.permute(*d))(o, 0, 2, 1, 3).reshape(B, Sq, Hq * Dh) @ wo

    def _B_ref(x, w1, w3, w2):
        gate = torch.einsum("bsd,df->bsf", x, w1)
        up = torch.einsum("bsd,df->bsf", x, w3)
        h = _silu(gate) * up
        out = torch.einsum("bsf,fd->bsd", h, w2)
        return out

    x = A_x
    x = x + _A_ref(_layernorm(x, axis=-1), A_k_cache, A_v_cache, A_wq, A_wo)
    x = x + _B_ref(_layernorm(x, axis=-1), B_w1, B_w3, B_w2)
    x = x + _A_ref(_layernorm(x, axis=-1), A_k_cache, A_v_cache, A_wq, A_wo)
    x = x + _B_ref(_layernorm(x, axis=-1), B_w1, B_w3, B_w2)
    return x
```

```asm
; @launch grid=(256,1,1) block=(512,1,1) lds=139264
.amdgcn_target "amdgcn-amd-amdhsa--gfx950"
.text
.globl interleave_layers__sliding_block_cached__glu_gated_swiglu__decode_kernel
.p2align 12
.fill 832, 4, 0xbf810000
.p2align 8
.type interleave_layers__sliding_block_cached__glu_gated_swiglu__decode_kernel,@function
interleave_layers__sliding_block_cached__glu_gated_swiglu__decode_kernel:
    v_readfirstlane_b32 s56, v0
    v_mov_b32 v5, 0
    s_cmpk_eq_u32 s56, 320
    s_cbranch_scc1 L_init
L_args:
    s_load_dwordx16 s[4:19], s[0:1], 0
    s_load_dwordx8 s[20:27], s[0:1], 64
    s_cmpk_ge_u32 s2, 256
    s_cbranch_scc1 L_exit
    s_lshr_b32 s56, s56, 6
    v_and_b32 v0, 63, v0
    s_and_b32 s52, s2, 7
    s_lshr_b32 s53, s2, 3
    s_and_b32 s54, s53, 3
    s_lshr_b32 s55, s53, 2
    s_mov_b32 s31, 0x20000
    s_lshl_b32 s38, 5, 20
    s_mov_b32 s39, s31
    s_mov_b32 s35, s31
    v_lshlrev_b32 v179, 4, v0
    v_lshrrev_b32 v1, 4, v0
    s_cmp_ge_u32 s56, 1
    s_cbranch_scc1 L_roles
    v_lshlrev_b32 v8, 1, v1
    v_and_b32 v6, 7, v0
    v_xor_b32 v6, v6, v8
    v_lshlrev_b32 v6, 4, v6
    v_lshrrev_b32 v7, 3, v0
    v_lshl_add_u32 v9, v7, 13, v6
    v_mov_b32 v3, -1
    v_add_u32 v12, 0xfc00, v9
    v_add_u32 v13, 0x1f800, v9
    v_add_u32 v14, 0x2f400, v9
    v_bfe_u32 v2, v0, 1, 1
    v_lshl_add_u32 v2, v1, 1, v2
    v_bfe_u32 v10, v0, 2, 2
    v_lshl_add_u32 v2, v2, 2, v10
    v_and_b32 v10, 1, v0
    v_lshl_add_u32 v2, v2, 1, v10
    v_lshlrev_b32 v2, 2, v2
    s_lshl_b32 s61, s54, 8
    s_movk_i32 s34, 1024
    s_lshl_b32 m0, 14, 12
    s_xor_b32 s65, s55, 1
    s_lshl3_add_u32 s65, s52, s65
    s_lshl_b32 s65, s65, 7
    s_lshr_b32 s46, s55, 1
    s_add_u32 s46, s46, s54
    s_and_b32 s46, s46, 3
    s_lshl2_add_u32 s47, s54, s46
    s_lshl_b32 s47, s47, 18
    s_add_u32 s65, s65, s47
    s_lshl_b32 s46, s46, 12
    v_and_b32 v4, 15, v0
    v_xor_b32 v4, v4, v8
    v_lshlrev_b32 v4, 4, v4
    v_lshl_add_u32 v4, v1, 8, v4
    v_xor_b32 v11, 0x80, v4
    s_lshl4_add_u32 s64, s52, 15
    s_lshl_b32 s64, s64, 20
    s_mul_i32 s67, s52, 4
    s_lshl_b32 s30, 1, 22
    s_barrier
    s_waitcnt lgkmcnt(0)
    s_mov_b64 s[32:33], s[4:5]
    s_mov_b64 s[28:29], s[10:11]
    buffer_load_dword v2, s[32:35], s61 offen lds
    s_mov_b32 m0, s46
    s_nop 0
    buffer_load_dwordx4 v9, s[28:31], s65 offen offset:0 nt lds
    buffer_load_dwordx4 v12, s[28:31], s65 offen offset:1024 nt lds
    buffer_load_dwordx4 v13, s[28:31], s65 offen offset:2048 nt lds
    buffer_load_dwordx4 v14, s[28:31], s65 offen offset:3072 nt lds
    s_xor_b32 m0, s46, 0x1000
    s_xor_b32 s65, s65, 0x40000
    buffer_load_dwordx4 v9, s[28:31], s65 offen offset:0 nt lds
    buffer_load_dwordx4 v12, s[28:31], s65 offen offset:1024 nt lds
    buffer_load_dwordx4 v13, s[28:31], s65 offen offset:2048 nt lds
    buffer_load_dwordx4 v14, s[28:31], s65 offen offset:3072 nt lds
    s_xor_b32 m0, s46, 0x2000
    s_xor_b32 s65, s65, 0xc0000
    buffer_load_dwordx4 v9, s[28:31], s65 offen offset:0 nt lds
    buffer_load_dwordx4 v12, s[28:31], s65 offen offset:1024 nt lds
    buffer_load_dwordx4 v13, s[28:31], s65 offen offset:2048 nt lds
    buffer_load_dwordx4 v14, s[28:31], s65 offen offset:3072 nt lds
    s_xor_b32 m0, s46, 0x3000
    s_xor_b32 s65, s65, 0x40000
    buffer_load_dwordx4 v9, s[28:31], s65 offen offset:0 nt lds
    buffer_load_dwordx4 v12, s[28:31], s65 offen offset:1024 nt lds
    buffer_load_dwordx4 v13, s[28:31], s65 offen offset:2048 nt lds
    buffer_load_dwordx4 v14, s[28:31], s65 offen offset:3072 nt lds
    s_mov_b64 s[28:29], s[6:7]
    s_brev_b32 s30, 16
    s_add_u32 s62, s67, 0
    s_add_u32 s63, s67, 8
L_ld1:
    s_and_b32 s44, s62, 7
    s_lshl_b32 s45, s44, 12
    s_add_u32 m0, s45, 0x10000
    s_mul_i32 s45, s44, 3
    s_add_u32 s45, s45, s53
    s_and_b32 s45, s45, 31
    s_lshl_b32 s44, s44, 5
    s_add_u32 s45, s45, s44
    s_lshl_b32 s45, s45, 12
    s_add_u32 s45, s45, s64
    buffer_load_dwordx4 v4, s[28:31], s45 offen offset:0 nt lds
    buffer_load_dwordx4 v11, s[28:31], s45 offen offset:1024 nt lds
    buffer_load_dwordx4 v4, s[28:31], s45 offen offset:2048 nt lds
    buffer_load_dwordx4 v11, s[28:31], s45 offen offset:3072 nt lds
    s_add_u32 s62, s62, 1
    v_add_u32 v3, 1, v3
    s_waitcnt vmcnt(20)
    ds_write_b32 v5, v3 offset:58240
    s_cmp_lg_u32 s62, s63
    s_cbranch_scc1 L_ld1
    s_branch L_loader2
L_init:
    v_lshlrev_b32 v2, 2, v0
    ds_write_b32 v2, v5 offset:56960
    s_waitcnt lgkmcnt(0)
    s_branch L_args
L_roles:
    s_cmp_eq_u32 s56, 1
    s_cbranch_scc1 L_helper
    s_cmp_ge_u32 s56, 6
    s_cbranch_scc1 L_probe
    s_sub_u32 s56, s56, 2
    s_cmp_ge_u32 s53, 3
    s_cbranch_scc1 L_nopf
    s_getpc_b64 s[32:33]
    s_and_b32 s32, s32, 0xfffffc00
    s_mov_b32 s34, L_hotend-interleave_layers__sliding_block_cached__glu_gated_swiglu__decode_kernel+1024
    s_lshl2_add_u32 s60, s53, s56
    s_lshl_b32 s60, s60, 10
    buffer_load_dwordx4 v[252:255], v179, s[32:35], s60 offen offset:1024
L_nopf:
    s_barrier
    s_branch L_setup
L_probe:
    s_xor_b32 s51, s56, s53
    s_and_b32 s51, s51, 1
    s_lshl1_add_u32 s48, s52, s51
    s_lshl_b32 s48, s48, 5
    s_add_u32 s48, s48, s53
    s_lshl_b32 s48, s48, 8
    s_barrier
    s_waitcnt lgkmcnt(0)
    s_add_u32 s36, s26, 0x1fffff
    s_addc_u32 s37, s27, 0
    s_and_b32 s36, s36, 0xffe00000
    s_memtime s[44:45]
    s_load_dword s50, s[36:37], s48 offset:0x60000
    s_waitcnt lgkmcnt(0)
    s_memtime s[46:47]
    s_branch L_probe2
L_exit:
    s_endpgm
L_helper:
    s_setprio 3
    v_mov_b32 v8, -1
    v_mov_b32 v9, -1
    v_mov_b32 v10, -1
    v_mov_b32 v11, -1
    v_and_b32 v2, 7, v0
    v_lshlrev_b32 v2, 7, v2
    s_lshl_b32 s64, s52, 12
    s_add_u32 s64, s64, 0x48000
    s_lshl_b32 s61, s52, 17
    s_add_u32 s61, s61, 0x200000
    s_lshl_b32 s66, s53, 11
    s_add_u32 s65, s61, s66
    s_cmp_gt_u32 s53, 25
    s_cselect_b32 s65, 0x3fe00000, s65
    s_andn2_b32 s44, 1, s55
    s_lshl_b32 s44, s44, 7
    s_lshl_b32 s45, s54, 2
    s_add_u32 s44, s44, s45
    s_lshr_b32 s45, s55, 1
    s_add_u32 s44, s44, s45
    s_lshl_b32 s44, s44, 4
    s_add_u32 s44, s44, 0x10000
    s_lshl_b32 s45, s54, 5
    s_add_u32 s45, s45, 0x11f00
    v_and_b32 v3, 7, v0
    v_lshl_add_u32 v3, v3, 8, s44
    v_bfe_u32 v4, v0, 3, 1
    v_lshl_add_u32 v3, v4, 12, v3
    v_cmp_gt_u32 vcc, 16, v0
    v_add_u32 v4, s45, v179
    s_cmp_eq_u32 s55, 0
    s_cselect_b32 s50, 18, 16
    s_bfm_b64 s[50:51], s50, 0
    v_cndmask_b32 v3, v4, v3, vcc
    s_mov_b64 exec, s[50:51]
    s_barrier
    s_waitcnt lgkmcnt(0)
    s_add_u32 s36, s26, 0x1fffff
    s_addc_u32 s37, s27, 0
    s_and_b32 s36, s36, 0xffe00000
    buffer_store_dwordx4 v[8:11], v3, s[36:39], s61 offen
    s_mov_b64 exec, -1
    buffer_store_dwordx4 v[8:11], v179, s[36:39], s65 offen offset:0
    buffer_store_dwordx4 v[8:11], v179, s[36:39], s65 offen offset:1024
    s_load_dword s57, s[36:37], 0x40000
    buffer_load_dword v12, v2, s[36:39], s64 offen sc1 nt
    s_branch L_helper2
L_probe2:
    s_mov_b64 exec, 1
    s_waitcnt lgkmcnt(0)
    s_sub_u32 s44, s46, s44
    s_min_u32 s44, s44, 0x3fff
    s_sub_u32 s45, 0x3fff, s44
    s_cmp_eq_u32 s51, 1
    s_cselect_b32 s44, s45, s44
    s_add_u32 s44, s44, 0x100000
    v_mov_b32 v14, s44
    ds_add_u32 v5, v14 offset:58260
    s_waitcnt lgkmcnt(0)
    s_mov_b64 exec, 0
    s_cmp_eq_u32 s56, 6
    s_cbranch_scc1 H9
    s_branch H16
L_loader2:
HC1:
H1:
    s_cbranch_execz L_exit
    s_lshl_b32 s66, s55, 7
    v_lshl_add_u32 v16, v7, 10, v6
    v_mul_u32_u24 v20, 3584, v7
    v_add_u32 v20, v20, v6
    v_add_u32 v17, 7168, v16
    v_add_u32 v21, 27648, v20
    v_add_u32 v18, 14336, v16
    v_add_u32 v22, 55296, v20
    v_add_u32 v19, 21504, v16
    v_add_u32 v23, 82944, v20
    s_lshl_b32 s65, s52, 2
    s_add_u32 s65, s65, s54
    s_lshl_b32 s65, s65, 17
    s_add_u32 s65, s65, s66
    s_mov_b32 s14, 0x400000
    s_mov_b32 s15, s31
    s_bitcmp1_b32 s55, 0
    s_cselect_b64 s[16:17], s[18:19], s[16:17]
    s_lshr_b32 s61, s55, 1
    s_lshr_b32 s46, s52, 2
    s_lshl_b32 s47, s52, 1
    s_sub_u32 s46, s47, s46
    s_lshl_b32 s46, s46, 1
    s_add_u32 s46, s46, s61
    s_lshl_b32 s46, s46, 7
    s_mul_i32 s60, s54, 458752
    s_add_u32 s60, s60, s46
    s_and_b32 s47, s52, 3
    s_lshl_b32 s47, s47, 2
    s_add_u32 s47, s47, s61
    s_cmp_ge_u32 s47, 14
    s_cselect_b32 s18, 0, 0x1c0000
    s_mov_b32 s19, s31
    s_lshr_b32 s46, s52, 2
    s_lshl_b32 s47, s52, 1
    s_sub_u32 s46, s47, s46
    s_lshl_b32 s46, s46, 1
    s_add_u32 s46, s46, s54
    s_lshl_b32 s61, s46, 16
    s_add_u32 s61, s61, s66
    s_and_b32 s47, s52, 3
    s_lshl_b32 s47, s47, 2
    s_add_u32 s47, s47, s54
    s_cmp_ge_u32 s47, 14
    s_cselect_b32 s22, 0, 0x1c0000
    s_mov_b32 s23, s31
    s_mov_b32 m0, 0x4000
    s_nop 0
    buffer_load_dwordx4 v16, s[12:15], s65 offen offset:0 nt lds
    buffer_load_dwordx4 v17, s[12:15], s65 offen offset:1024 nt lds
    buffer_load_dwordx4 v18, s[12:15], s65 offen offset:2048 nt lds
    buffer_load_dwordx4 v19, s[12:15], s65 offen offset:3072 nt lds
    v_add_u32 v3, 1, v3
    s_waitcnt vmcnt(20)
    ds_write_b32 v5, v3 offset:58240
    s_mov_b32 m0, 0xc000
    s_nop 0
    buffer_load_dwordx4 v16, s[20:23], s61 offen offset:0 nt lds
    buffer_load_dwordx4 v17, s[20:23], s61 offen offset:1024 nt lds
    buffer_load_dwordx4 v18, s[20:23], s61 offen offset:2048 nt lds
    buffer_load_dwordx4 v19, s[20:23], s61 offen offset:3072 nt lds
    v_add_u32 v3, 1, v3
    s_waitcnt vmcnt(20)
    ds_write_b32 v5, v3 offset:58240
    s_mov_b64 s[32:33], s[8:9]
    s_brev_b32 s34, 16
    s_add_u32 s62, s67, 0
    s_add_u32 s63, s67, 8
L_ld2:
    s_and_b32 s44, s62, 7
    s_lshl_b32 s45, s44, 12
    s_add_u32 m0, s45, 0x18000
    s_mul_i32 s45, s44, 3
    s_add_u32 s45, s45, s53
    s_and_b32 s45, s45, 31
    s_lshl_b32 s44, s44, 5
    s_add_u32 s45, s45, s44
    s_lshl_b32 s45, s45, 12
    s_add_u32 s45, s45, s64
    buffer_load_dwordx4 v4, s[32:35], s45 offen offset:0 nt lds
    buffer_load_dwordx4 v11, s[32:35], s45 offen offset:1024 nt lds
    buffer_load_dwordx4 v4, s[32:35], s45 offen offset:2048 nt lds
    buffer_load_dwordx4 v11, s[32:35], s45 offen offset:3072 nt lds
    s_add_u32 s62, s62, 1
    v_add_u32 v3, 1, v3
    s_waitcnt vmcnt(20)
    ds_write_b32 v5, v3 offset:58240
    s_cmp_lg_u32 s62, s63
    s_cbranch_scc1 L_ld2
    s_mov_b32 m0, 0x5000
    s_add_u32 s65, s65, 32768
    buffer_load_dwordx4 v16, s[12:15], s65 offen offset:0 nt lds
    buffer_load_dwordx4 v17, s[12:15], s65 offen offset:1024 nt lds
    buffer_load_dwordx4 v18, s[12:15], s65 offen offset:2048 nt lds
    buffer_load_dwordx4 v19, s[12:15], s65 offen offset:3072 nt lds
    v_add_u32 v3, 1, v3
    s_waitcnt vmcnt(20)
    ds_write_b32 v5, v3 offset:58240
    s_mov_b32 m0, 0x8000
    s_nop 0
    buffer_load_dwordx4 v20, s[16:19], s60 offen offset:0 nt lds
    buffer_load_dwordx4 v21, s[16:19], s60 offen offset:1024 nt lds
    buffer_load_dwordx4 v22, s[16:19], s60 offen offset:2048 nt lds
    buffer_load_dwordx4 v23, s[16:19], s60 offen offset:3072 nt lds
    v_add_u32 v3, 1, v3
    s_waitcnt vmcnt(20)
    ds_write_b32 v5, v3 offset:58240
    s_mov_b32 m0, 0x6000
    s_add_u32 s65, s65, 32768
    buffer_load_dwordx4 v16, s[12:15], s65 offen offset:0 nt lds
    buffer_load_dwordx4 v17, s[12:15], s65 offen offset:1024 nt lds
    buffer_load_dwordx4 v18, s[12:15], s65 offen offset:2048 nt lds
    buffer_load_dwordx4 v19, s[12:15], s65 offen offset:3072 nt lds
    v_add_u32 v3, 1, v3
    s_waitcnt vmcnt(20)
    ds_write_b32 v5, v3 offset:58240
    s_mov_b32 m0, 0x9000
    s_add_u32 s60, s60, 114688
    buffer_load_dwordx4 v20, s[16:19], s60 offen offset:0 nt lds
    buffer_load_dwordx4 v21, s[16:19], s60 offen offset:1024 nt lds
    buffer_load_dwordx4 v22, s[16:19], s60 offen offset:2048 nt lds
    buffer_load_dwordx4 v23, s[16:19], s60 offen offset:3072 nt lds
    v_add_u32 v3, 1, v3
    s_waitcnt vmcnt(20)
    ds_write_b32 v5, v3 offset:58240
    s_mov_b32 m0, 0x7000
    s_add_u32 s65, s65, 32768
    buffer_load_dwordx4 v16, s[12:15], s65 offen offset:0 nt lds
    buffer_load_dwordx4 v17, s[12:15], s65 offen offset:1024 nt lds
    buffer_load_dwordx4 v18, s[12:15], s65 offen offset:2048 nt lds
    buffer_load_dwordx4 v19, s[12:15], s65 offen offset:3072 nt lds
    v_add_u32 v3, 1, v3
    s_waitcnt vmcnt(20)
    ds_write_b32 v5, v3 offset:58240
    s_mov_b32 m0, 0xa000
    s_add_u32 s60, s60, 114688
    buffer_load_dwordx4 v20, s[16:19], s60 offen offset:0 nt lds
    buffer_load_dwordx4 v21, s[16:19], s60 offen offset:1024 nt lds
    buffer_load_dwordx4 v22, s[16:19], s60 offen offset:2048 nt lds
    buffer_load_dwordx4 v23, s[16:19], s60 offen offset:3072 nt lds
    v_add_u32 v3, 1, v3
    s_waitcnt vmcnt(20)
    ds_write_b32 v5, v3 offset:58240
    s_mov_b32 m0, 0xd000
    s_add_u32 s61, s61, 32768
    buffer_load_dwordx4 v16, s[20:23], s61 offen offset:0 nt lds
    buffer_load_dwordx4 v17, s[20:23], s61 offen offset:1024 nt lds
    buffer_load_dwordx4 v18, s[20:23], s61 offen offset:2048 nt lds
    buffer_load_dwordx4 v19, s[20:23], s61 offen offset:3072 nt lds
    v_add_u32 v3, 1, v3
    s_waitcnt vmcnt(20)
    ds_write_b32 v5, v3 offset:58240
    s_mov_b32 m0, 0xb000
    s_add_u32 s60, s60, 114688
    buffer_load_dwordx4 v20, s[16:19], s60 offen offset:0 nt lds
    buffer_load_dwordx4 v21, s[16:19], s60 offen offset:1024 nt lds
    buffer_load_dwordx4 v22, s[16:19], s60 offen offset:2048 nt lds
    buffer_load_dwordx4 v23, s[16:19], s60 offen offset:3072 nt lds
    v_add_u32 v3, 1, v3
    s_waitcnt vmcnt(20)
    ds_write_b32 v5, v3 offset:58240
    s_mov_b64 exec, 1
    v_add_u32 v3, 1, v3
    s_waitcnt vmcnt(16)
    ds_write_b32 v5, v3 offset:58240
    v_add_u32 v3, 1, v3
    s_waitcnt vmcnt(12)
    ds_write_b32 v5, v3 offset:58240
    v_add_u32 v3, 1, v3
    s_waitcnt vmcnt(8)
    ds_write_b32 v5, v3 offset:58240
    v_add_u32 v3, 1, v3
    s_waitcnt vmcnt(4)
    ds_write_b32 v5, v3 offset:58240
    v_add_u32 v3, 1, v3
    s_waitcnt vmcnt(0)
    ds_write_b32 v5, v3 offset:58240
    s_mov_b64 exec, -1
    s_waitcnt lgkmcnt(0)
    s_endpgm
L_helper2:
HC2:
H2:
    s_cbranch_execz H1
    s_getreg_b32 s67, hwreg(HW_REG_XCC_ID)
    s_and_b32 s67, s67, 7
    s_add_u32 s40, s36, s64
    s_addc_u32 s41, s37, 0
    s_lshl_b32 s66, s53, 2
    s_add_u32 s66, s66, s64
    s_lshl_b32 s62, s52, 12
    s_add_u32 s62, s62, 0x50000
    s_lshl_b32 s63, s53, 7
    s_add_u32 s63, s63, s62
    s_mov_b32 s59, 65536
    v_mov_b32 v6, 1
    s_waitcnt vmcnt(1)
    ds_write_b32 v5, v6 offset:58264
    s_mov_b32 s48, 0x200000
L_w1:
    ds_read_b32 v15, v5 offset:58260
    s_waitcnt lgkmcnt(0)
    v_cmp_gt_i32 vcc, s48, v15
    s_cbranch_vccnz L_w1
    v_readfirstlane_b32 s48, v15
    s_cmp_gt_u32 s48, 0x203faf
    s_cselect_b32 s49, 8, 0
    s_cmp_gt_u32 s48, 0x20404f
    s_cselect_b32 s49, 16, s49
    s_add_u32 s57, s57, 0x9e376001
    s_and_b32 s57, s57, 0xffffffe0
    s_or_b32 s42, s57, s67
    s_mov_b32 s43, s42
    s_or_b32 s49, s49, s42
    v_mov_b32 v13, s49
    s_bfm_b64 exec, 8, 0
    buffer_store_dword v13, v2, s[36:39], s66 offen
    s_mov_b64 exec, -1
    s_mov_b32 s44, s65
    buffer_load_dwordx4 v[20:23], v179, s[36:39], s44 offen offset:0 sc1 nt
    buffer_load_dwordx4 v[24:27], v179, s[36:39], s44 offen offset:1024 sc1 nt
    s_mov_b32 s48, 10
    s_mov_b32 s66, 8
    s_waitcnt vmcnt(2)
L_hpoll:
L_w2:
    ds_read_b32 v15, v5 offset:58240
    s_waitcnt lgkmcnt(0)
    v_cmp_gt_i32 vcc, s48, v15
    s_cbranch_vccnz L_w2
    v_readfirstlane_b32 s48, v15
    s_load_dwordx16 s[4:19], s[40:41], 0
    s_load_dwordx16 s[20:35], s[40:41], 64
    s_waitcnt lgkmcnt(0)
    s_xor_b64 s[44:45], s[4:5], s[42:43]
    s_xor_b64 s[46:47], s[6:7], s[42:43]
    s_or_b64 s[44:45], s[44:45], s[46:47]
    s_xor_b64 s[46:47], s[8:9], s[42:43]
    s_or_b64 s[44:45], s[44:45], s[46:47]
    s_xor_b64 s[46:47], s[10:11], s[42:43]
    s_or_b64 s[44:45], s[44:45], s[46:47]
    s_xor_b64 s[46:47], s[12:13], s[42:43]
    s_or_b64 s[44:45], s[44:45], s[46:47]
    s_xor_b64 s[46:47], s[14:15], s[42:43]
    s_or_b64 s[44:45], s[44:45], s[46:47]
    s_xor_b64 s[46:47], s[16:17], s[42:43]
    s_or_b64 s[44:45], s[44:45], s[46:47]
    s_xor_b64 s[46:47], s[18:19], s[42:43]
    s_or_b64 s[44:45], s[44:45], s[46:47]
    s_xor_b64 s[46:47], s[20:21], s[42:43]
    s_or_b64 s[44:45], s[44:45], s[46:47]
    s_xor_b64 s[46:47], s[22:23], s[42:43]
    s_or_b64 s[44:45], s[44:45], s[46:47]
    s_xor_b64 s[46:47], s[24:25], s[42:43]
    s_or_b64 s[44:45], s[44:45], s[46:47]
    s_xor_b64 s[46:47], s[26:27], s[42:43]
    s_or_b64 s[44:45], s[44:45], s[46:47]
    s_xor_b64 s[46:47], s[28:29], s[42:43]
    s_or_b64 s[44:45], s[44:45], s[46:47]
    s_xor_b64 s[46:47], s[30:31], s[42:43]
    s_or_b64 s[44:45], s[44:45], s[46:47]
    s_xor_b64 s[46:47], s[32:33], s[42:43]
    s_or_b64 s[44:45], s[44:45], s[46:47]
    s_xor_b64 s[46:47], s[34:35], s[42:43]
    s_or_b64 s[44:45], s[44:45], s[46:47]
    s_or_b32 s44, s44, s45
    s_andn2_b32 s44, s44, 24
    s_cbranch_scc0 L_hfast
    s_add_u32 s40, s40, 128
    s_addc_u32 s41, s41, 0
    s_add_u32 s48, s48, 1
    s_min_u32 s48, s48, 20
    s_sub_u32 s66, s66, 1
    s_cmp_lg_u32 s66, 0
    s_cbranch_scc1 L_hpoll
    s_branch L_hvec
L_hfast:
    s_mov_b64 exec, 1
    v_mov_b32 v13, 0x10001
    ds_add_u32 v5, v13 offset:58244
    s_add_u32 s4, s4, s5
    s_add_u32 s4, s4, s6
    s_add_u32 s4, s4, s7
    s_add_u32 s4, s4, s8
    s_add_u32 s4, s4, s9
    s_add_u32 s4, s4, s10
    s_add_u32 s4, s4, s11
    s_add_u32 s4, s4, s12
    s_add_u32 s4, s4, s13
    s_add_u32 s4, s4, s14
    s_add_u32 s4, s4, s15
    s_add_u32 s4, s4, s16
    s_add_u32 s4, s4, s17
    s_add_u32 s4, s4, s18
    s_add_u32 s4, s4, s19
    s_add_u32 s4, s4, s20
    s_add_u32 s4, s4, s21
    s_add_u32 s4, s4, s22
    s_add_u32 s4, s4, s23
    s_add_u32 s4, s4, s24
    s_add_u32 s4, s4, s25
    s_add_u32 s4, s4, s26
    s_add_u32 s4, s4, s27
    s_add_u32 s4, s4, s28
    s_add_u32 s4, s4, s29
    s_add_u32 s4, s4, s30
    s_add_u32 s4, s4, s31
    s_add_u32 s4, s4, s32
    s_add_u32 s4, s4, s33
    s_add_u32 s4, s4, s34
    s_add_u32 s4, s4, s35
    s_lshl_b32 s5, s42, 5
    s_sub_u32 s4, s4, s5
    s_cmp_gt_u32 s4, 256
    s_cselect_b32 s49, 16, 0
L_hok:
    s_and_b32 s49, s49, 16
    s_lshl_b32 s49, s49, 9
    v_mov_b32 v13, s49
    ds_write_b32 v5, v13 offset:58256
    s_mov_b64 exec, -1
    s_lshl_b32 s4, s52, 14
    s_lshl_b32 s5, s54, 11
    s_add_u32 s4, s4, s5
    s_lshl_b32 s5, s55, 8
    s_add_u32 s4, s4, s5
    v_and_b32 v3, 15, v0
    v_lshlrev_b32 v3, 4, v3
    v_and_b32 v7, 1, v1
    v_lshl_add_u32 v3, v7, 17, v3
    v_lshrrev_b32 v7, 5, v0
    v_lshl_add_u32 v3, v7, 13, v3
    s_lshr_b32 s6, s55, 1
    s_lshl_b32 s6, s6, 14
    s_and_b32 s7, s55, 1
    s_lshl_b32 s7, s7, 12
    s_add_u32 s6, s6, s7
    s_lshl_b32 s7, s52, 2
    s_add_u32 s7, s7, s54
    s_lshl_b32 s7, s7, 6
    s_add_u32 s6, s6, s7
    s_add_u32 s6, s6, 0x80000
    v_and_b32 v4, 3, v0
    v_lshlrev_b32 v4, 4, v4
    v_bfe_u32 v7, v0, 2, 1
    v_lshl_add_u32 v4, v7, 11, v4
    v_bfe_u32 v7, v0, 3, 1
    v_lshl_add_u32 v4, v7, 13, v4
    v_lshl_add_u32 v4, v1, 16, v4
L_w3:
    ds_read_b32 v15, v5 offset:58240
    s_waitcnt lgkmcnt(0)
    v_cmp_gt_i32 vcc, 23, v15
    s_cbranch_vccnz L_w3
    buffer_store_dwordx4 v[8:11], v3, s[36:39], s4 offen sc1
    s_bfm_b64 exec, 32, 0
    buffer_store_dwordx4 v[8:11], v4, s[36:39], s6 offen sc1
L_hdone:
    s_waitcnt vmcnt(0) lgkmcnt(0)
    s_endpgm
L_setup:
    v_and_b32 v2, 3, v0
    v_bfe_u32 v3, v0, 2, 2
    v_and_b32 v10, 1, v1
    v_lshl_add_u32 v10, v2, 1, v10
    v_lshl_add_u32 v10, v10, 2, v3
    v_bfe_u32 v9, v0, 3, 2
    s_lshl_b32 s60, s54, 2
    s_add_u32 s67, s60, s56
    s_lshl_b32 s60, s67, 6
    v_lshl_add_u32 v200, v10, 1, s60
    s_mov_b32 s30, 1024
    s_waitcnt lgkmcnt(0)
    s_add_u32 s36, s26, 0x1fffff
    s_addc_u32 s37, s27, 0
    s_and_b32 s36, s36, 0xffe00000
    s_mov_b64 s[28:29], s[22:23]
    s_mov_b32 s68, 0
    s_mov_b32 s69, -1
    s_mov_b32 s59, 65536
    v_mov_b32 v6, 1
    v_mov_b32 v202, -1
    v_and_b32 v12, 15, v0
    v_mov_b32 v13, 0x3ff00000
    v_cmp_gt_u32 s[62:63], 32, v0
    v_and_b32 v14, 1, v0
    v_lshlrev_b32 v14, 4, v14
    v_mov_b32 v15, 0xffff
    v_lshlrev_b32 v14, v14, v15
    v_lshrrev_b32 v15, 1, v12
    v_cmp_eq_u32 s[4:5], 0, v15
    v_cmp_eq_u32 s[6:7], 1, v15
    v_cmp_eq_u32 s[8:9], 2, v15
    v_cmp_eq_u32 s[10:11], 3, v15
    v_cmp_eq_u32 s[12:13], 4, v15
    v_cmp_eq_u32 s[14:15], 5, v15
    v_cmp_eq_u32 s[16:17], 6, v15
    v_cmp_eq_u32 s[18:19], 7, v15
    v_cndmask_b32 v148, 0, v14, s[4:5]
    v_cndmask_b32 v149, 0, v14, s[6:7]
    v_cndmask_b32 v150, 0, v14, s[8:9]
    v_cndmask_b32 v151, 0, v14, s[10:11]
    v_cndmask_b32 v152, 0, v14, s[12:13]
    v_cndmask_b32 v153, 0, v14, s[14:15]
    v_cndmask_b32 v154, 0, v14, s[16:17]
    v_cndmask_b32 v155, 0, v14, s[18:19]
    v_lshrrev_b32 v15, 3, v12
    v_sub_u32 v15, v1, v15
    v_cmp_eq_u32 s[4:5], 0, v15
    v_cmp_eq_u32 s[6:7], 2, v15
    v_mov_b32 v156, 0x3f803f80
    v_or_b32 v136, v148, v152
    v_and_b32 v136, v156, v136
    v_mov_b32 v157, 0x3f803f80
    v_or_b32 v137, v149, v153
    v_and_b32 v137, v157, v137
    v_mov_b32 v158, 0x3f803f80
    v_or_b32 v138, v150, v154
    v_and_b32 v138, v158, v138
    v_mov_b32 v159, 0x3f803f80
    v_or_b32 v139, v151, v155
    v_and_b32 v139, v159, v139
    v_cndmask_b32 v140, 0, v136, s[4:5]
    v_cndmask_b32 v141, 0, v137, s[4:5]
    v_cndmask_b32 v142, 0, v138, s[4:5]
    v_cndmask_b32 v143, 0, v139, s[4:5]
    v_cndmask_b32 v144, 0, v136, s[6:7]
    v_cndmask_b32 v145, 0, v137, s[6:7]
    v_cndmask_b32 v146, 0, v138, s[6:7]
    v_cndmask_b32 v147, 0, v139, s[6:7]
    v_and_b32 v14, 1, v0
    v_bfe_u32 v15, v0, 2, 1
    v_lshl_add_u32 v15, v15, 1, v14
    v_mov_b32 v14, 1.0
    v_cmp_eq_u32 s[4:5], 0, v15
    v_cmp_eq_u32 s[6:7], 1, v15
    v_cmp_eq_u32 s[8:9], 2, v15
    v_cmp_eq_u32 s[10:11], 3, v15
    v_cndmask_b32 v152, 0, v14, s[4:5]
    v_cndmask_b32 v153, 0, v14, s[6:7]
    v_cndmask_b32 v154, 0, v14, s[8:9]
    v_cndmask_b32 v155, 0, v14, s[10:11]
    v_lshrrev_b32 v14, 5, v0
    v_lshlrev_b32 v14, 14, v14
    v_lshl_add_u32 v14, v9, 11, v14
    v_and_b32 v15, 7, v0
    v_lshl_add_u32 v14, v15, 4, v14
    s_lshl_b32 s48, s67, 7
    s_and_b32 s49, s52, 1
    s_lshl_b32 s49, s49, 17
    s_add_u32 s48, s48, s49
    v_add_u32 v10, s48, v14
    s_lshl_b32 s48, s52, 14
    s_lshl_b32 s49, s54, 11
    s_add_u32 s48, s48, s49
    s_lshl_b32 s49, s55, 8
    s_add_u32 s48, s48, s49
    s_lshl_b32 s49, s56, 6
    s_add_u32 s48, s48, s49
    v_lshl_add_u32 v14, v12, 2, s48
    v_and_b32 v7, 1, v1
    v_lshrrev_b32 v8, 5, v0
    v_lshl_add_u32 v14, v7, 17, v14
    v_lshl_add_u32 v11, v8, 13, v14
    v_bfe_u32 v14, v0, 2, 1
    v_lshlrev_b32 v14, 3, v14
    v_lshl_add_u32 v14, v2, 4, v14
    v_lshl_add_u32 v14, v9, 1, v14
    v_add_u32 v4, s49, v14
HC3:
    s_branch H3
.p2align 12
H3:
    s_cbranch_execz H2
    s_and_b32 s48, s52, 1
    s_lshl_b32 s48, s48, 2
    s_add_u32 s48, s48, s54
    s_lshl_b32 s48, s48, 3
    s_add_u32 s48, s48, s56
    s_lshl_b32 s48, s48, 11
    v_add_u32 v176, s48, v179
    s_lshr_b32 s48, s55, 1
    s_lshl_b32 s48, s48, 14
    s_and_b32 s49, s55, 1
    s_lshl_b32 s49, s49, 12
    s_add_u32 s48, s48, s49
    s_lshr_b32 s49, s56, 1
    s_lshl_b32 s49, s49, 11
    s_add_u32 s48, s48, s49
    s_and_b32 s49, s56, 1
    s_lshl_b32 s49, s49, 5
    s_add_u32 s48, s48, s49
    s_lshl_b32 s49, s52, 2
    s_add_u32 s49, s49, s54
    s_lshl_b32 s49, s49, 6
    s_add_u32 s48, s48, s49
    v_lshl_add_u32 v14, v12, 1, s48
    v_lshl_add_u32 v14, v7, 16, v14
    v_lshl_add_u32 v177, v8, 13, v14
    s_lshl_b32 s48, s56, 10
    v_add_u32 v203, s48, v179
    s_load_dword s57, s[36:37], 0x40000
    s_and_b32 s50, s55, 1
    s_xor_b32 s48, s50, 1
    s_lshl_b32 s48, s48, 2
    s_add_u32 s48, s48, s56
    s_lshl_b32 s48, s48, 9
    s_lshl_b32 s49, s54, 2
    s_lshr_b32 s51, s55, 1
    s_add_u32 s49, s49, s51
    s_lshl_b32 s49, s49, 4
    s_add_u32 s48, s48, s49
    s_add_u32 s48, s48, 0x10000
    v_lshrrev_b32 v14, 3, v12
    v_lshlrev_b32 v14, 8, v14
    v_and_b32 v15, 7, v0
    v_lshl_add_u32 v14, v15, 1, v14
    v_lshl_add_u32 v14, v1, 12, v14
    v_add_u32 v14, s48, v14
    v_cndmask_b32 v178, v13, v14, s[62:63]
    s_lshl_b32 s48, s51, 10
    s_lshl_b32 s49, s56, 8
    s_add_u32 s48, s48, s49
    s_lshl_b32 s49, s50, 3
    s_add_u32 s48, s48, s49
    s_lshl_b32 s49, s54, 1
    s_add_u32 s48, s48, s49
    s_add_u32 s48, s48, 0x9000
    v_lshl_add_u32 v14, v12, 4, s48
    v_lshl_add_u32 v14, v1, 12, v14
    v_cndmask_b32 v186, v13, v14, s[62:63]
    s_lshl_b32 s48, s54, 10
    s_add_u32 s48, s48, 0x9000
    v_add_u32 v187, s48, v179
    v_lshlrev_b32 v14, 3, v12
    v_add_u32 v180, 0xc800, v14
    s_lshl_b32 s49, s54, 8
    s_add_u32 s49, s49, 0xc000
    v_lshrrev_b32 v15, 5, v0
    v_lshl_add_u32 v14, v15, 7, v14
    v_add_u32 v185, s49, v14
    s_lshl_b32 s48, s67, 3
    s_add_u32 s48, s48, 0xc800
    v_and_b32 v15, 0x2f, v0
    v_cmp_eq_u32 vcc, 0, v15
    v_lshl_add_u32 v14, v1, 2, s48
    s_nop 0
    v_cndmask_b32 v181, v13, v14, vcc
    v_cmp_eq_u32 vcc, s56, v0
    s_lshl_b32 s48, s56, 11
    s_lshl_b32 s49, s53, 6
    s_add_u32 s48, s48, s49
    v_and_b32 v14, 60, v0
    v_add_u32 v14, s48, v14
    v_lshl_add_u32 v182, v2, 13, v14
    s_lshl_b32 s48, s56, 1
    s_add_u32 s48, s48, s50
    s_lshl_b32 s48, s48, 2
    s_add_u32 s48, s48, s54
    s_lshl_b32 s48, s48, 2
    s_add_u32 s48, s48, s51
    s_lshl_b32 s48, s48, 3
    s_add_u32 s48, s48, 0xc000
    v_mov_b32 v14, s48
    v_cndmask_b32 v183, v13, v14, vcc
    s_lshl_b32 s48, s67, 11
    v_add_u32 v184, s48, v179
    s_lshl_b32 s49, s56, 6
    v_lshrrev_b32 v9, 2, v0
HC4:
H4:
    s_cbranch_execz H3
    v_and_b32 v14, 1, v2
    v_and_b32 v15, 1, v1
    v_lshl_add_u32 v14, v14, 1, v15
    v_lshlrev_b32 v14, 4, v14
    v_lshrrev_b32 v15, 1, v2
    v_lshl_add_u32 v14, v15, 3, v14
    v_lshl_add_u32 v14, v3, 1, v14
    v_add_u32 v188, s49, v14
    v_cmp_eq_u32 vcc, 1, v3
    v_lshl_add_u32 v190, v1, 4, s49
    v_xor_b32 v14, 18, v1
    v_lshlrev_b32 v14, 4, v14
    v_cndmask_b32 v189, v190, v14, vcc
    v_lshlrev_b32 v15, 6, v2
    v_xor_b32 v15, v15, v190
    v_cndmask_b32 v189, v15, v14, vcc
    v_mov_b32 v190, v15
    v_lshlrev_b32 v14, 6, v1
    v_lshl_add_u32 v14, v2, 4, v14
    v_add_u32 v14, 59392, v14
    v_mov_b32 v168, v14
    v_xor_b32 v169, 0x80, v14
    s_lshl_b32 s48, s56, 8
    v_lshl_add_u32 v15, v3, 2, v14
    v_add_u32 v15, s48, v15
    s_and_b32 s48, s49, 0x80
    v_xor_b32 v191, s48, v15
    v_lshl_add_u32 v14, v3, 8, v14
    v_and_b32 v15, 8, v0
    v_lshlrev_b32 v15, 4, v15
    v_xor_b32 v192, v14, v15
    v_cmp_eq_u32 s[4:5], 0, v3
    v_cmp_eq_u32 s[6:7], 1, v3
    v_cmp_eq_u32 s[8:9], 2, v3
    v_cmp_eq_u32 s[10:11], 3, v3
    v_cndmask_b32 v170, v13, v182, s[4:5]
    v_mov_b32 v15, 58112
    v_cndmask_b32 v160, v15, v192, s[4:5]
    v_cndmask_b32 v161, v15, v192, s[6:7]
    v_cndmask_b32 v162, v15, v192, s[8:9]
    v_cndmask_b32 v163, v15, v192, s[10:11]
    ds_write_b32 v15, v5
    ds_write_b32 v15, v5 offset:4
    ds_write_b32 v15, v5 offset:8
    ds_write_b32 v15, v5 offset:12
    v_lshrrev_b32 v14, 5, v0
    v_lshlrev_b32 v14, 6, v14
    v_lshl_add_u32 v14, v3, 4, v14
    v_and_b32 v15, 1, v1
    v_lshl_add_u32 v14, v15, 3, v14
    v_lshl_add_u32 v14, v2, 1, v14
    s_mov_b32 s48, 0
    v_add_u32 v193, s48, v14
    v_lshlrev_b32 v194, 4, v1
    v_and_b32 v14, 1, v0
    v_lshl_add_u32 v194, v14, 6, v194
    v_bfe_u32 v15, v0, 3, 2
    v_xor_b32 v15, s56, v15
    v_lshlrev_b32 v15, 5, v15
    v_lshl_add_u32 v14, v9, 7, v15
    v_lshl_add_u32 v14, v2, 3, v14
    s_lshl_b32 s48, s56, 12
    v_add_u32 v201, s48, v14
    v_lshlrev_b32 v14, 2, v0
    ds_write_b32 v14, v156 offset:57600
    ds_write_b32 v14, v156 offset:59136
    v_and_b32 v14, 7, v0
    v_lshlrev_b32 v14, 1, v14
    v_xor_b32 v14, v14, v1
    v_lshlrev_b32 v14, 4, v14
    v_lshl_add_u32 v14, v12, 8, v14
    s_lshl_b32 s48, s56, 13
    s_add_u32 s48, s48, 0x10000
    v_add_u32 v7, s48, v14
    v_xor_b32 v7, s49, v7
    s_lshl_b32 s48, s56, 1
    v_lshrrev_b32 v14, 1, v2
    v_add_u32 v14, s48, v14
    v_and_b32 v15, 7, v9
    v_xor_b32 v14, v14, v15
    v_lshlrev_b32 v14, 5, v14
    v_lshl_add_u32 v14, v9, 8, v14
    v_and_b32 v15, 1, v0
    v_lshl_add_u32 v14, v15, 4, v14
    v_add_u32 v8, 0x18000, v14
    s_waitcnt vmcnt(0) lgkmcnt(0)
    v_cndmask_b32 v200, v13, v200, s[62:63]
    s_add_u32 s57, s57, 0x9e376001
    s_and_b32 s4, s57, 0x1fff
    s_or_b32 s4, s4, 0x2000
    s_lshl_b32 s5, s4, 16
    s_lshl_b32 s48, s52, 17
    s_add_u32 s48, s48, 0x200000
    s_add_u32 s40, s36, s48
    s_addc_u32 s41, s37, 0
    s_mov_b32 s42, 0x20000
    s_mov_b32 s43, 0x20000
    s_mov_b32 s64, 0x2000
    s_mov_b32 s65, 0x10000
    s_mov_b32 s66, 0x11000
    s_mov_b32 s60, 0x5800
    v_add_u32 v164, 0x20000, v203
    v_xor_b32 v165, 1024, v164
    v_xor_b32 v166, 2048, v164
    v_xor_b32 v167, 3072, v164
    s_mov_b32 s46, 0x3b000000
    s_mov_b32 s47, s46
    s_mov_b32 s10, 0x42000000
    s_mov_b32 s12, 0x000f000f
    s_mov_b32 s13, s12
    s_lshl_b64 s[14:15], s[12:13], 4
    s_lshl_b64 s[16:17], s[12:13], 8
    s_lshl_b64 s[18:19], s[12:13], 12
L_w4:
    ds_read_b32 v15, v5 offset:58240
    s_waitcnt lgkmcnt(0)
    v_cmp_gt_i32 vcc, 4, v15
    s_cbranch_vccnz L_w4
    ds_read_u16_d16_hi v195, v4 offset:57344
    ds_read_b64_tr_b16 v[16:17], v201 offset:0
    ds_read_b64_tr_b16 v[18:19], v201 offset:2048
    v_xor_b32 v15, 4096, v201
    ds_read_b64_tr_b16 v[20:21], v15 offset:0
    ds_read_b64_tr_b16 v[22:23], v15 offset:2048
    v_xor_b32 v15, 8192, v201
    ds_read_b64_tr_b16 v[24:25], v15 offset:0
    ds_read_b64_tr_b16 v[26:27], v15 offset:2048
    v_xor_b32 v15, 12288, v201
    ds_read_b64_tr_b16 v[28:29], v15 offset:0
    ds_read_b64_tr_b16 v[30:31], v15 offset:2048
HC5:
H5:
    s_cbranch_execz H4
L_w5:
    ds_read_b32 v15, v5 offset:58264
    s_waitcnt lgkmcnt(0)
    v_cmp_gt_i32 vcc, 1, v15
    s_cbranch_vccnz L_w5
    v_and_b32 v195, 0xffff0000, v195
    s_mov_b32 s45, 0x3727c5ac
    ds_read_b128 v[204:207], v189 offset:57344
    v_mul_f32 v228, v195, v195
    s_cmp_eq_u32 s55, 0
    s_cselect_b32 s48, s60, 0x3ff00000
    v_mov_b32 v229, v195
    s_nop 1
    v_permlane16_swap_b32 v228, v229
    v_add_f32 v228, v228, v229
    s_nop 1
    v_add_f32_dpp v228, v228, v228 quad_perm:[1,0,3,2] row_mask:0xf bank_mask:0xf
    s_nop 1
    v_add_f32_dpp v228, v228, v228 quad_perm:[2,3,0,1] row_mask:0xf bank_mask:0xf
    s_nop 1
    v_add_f32_dpp v228, v228, v228 row_ror:4 row_mask:0xf bank_mask:0xf
    s_nop 1
    v_add_f32_dpp v228, v228, v228 row_ror:8 row_mask:0xf bank_mask:0xf
    buffer_store_dword v228, v181, s[40:43], s48 offen offset:0
    s_waitcnt lgkmcnt(0)
    v_mfma_f32_16x16x32_bf16 v[208:211], v[204:207], v[16:19], 0
    v_mfma_f32_16x16x32_bf16 v[212:215], v[204:207], v[20:23], 0
    v_mfma_f32_16x16x32_bf16 v[216:219], v[204:207], v[24:27], 0
    v_mfma_f32_16x16x32_bf16 v[220:223], v[204:207], v[28:31], 0
    v_add_f32 v208, v208, v213
    s_nop 2
    v_add_f32 v208, v208, v218
    s_nop 2
    v_add_f32 v208, v208, v223
    v_cvt_pk_bf16_f32 v208, v208, v208
    buffer_store_short v208, v178, s[40:43], 0 offen offset:0
L_w6:
    ds_read_b32 v15, v5 offset:58244
    s_waitcnt lgkmcnt(0)
    v_and_b32 v14, 0xffff, v15
    v_cmp_gt_i32 vcc, 1, v14
    s_cbranch_vccnz L_w6
    v_readfirstlane_b32 s44, v15
    s_nop 0
    s_lshr_b32 s44, s44, 16
    s_cbranch_scc0 L_slow
    v_cmp_gt_u32 vcc, 16, v0
    v_subrev_u32 v178, 0x8000, v178
    s_nop 0
    v_cndmask_b32 v178, v13, v178, vcc
    s_waitcnt vmcnt(0)
    buffer_load_dwordx2 v[220:221], v180, s[40:43], s60 offen offset:0 sc1
    buffer_load_dwordx4 v[204:207], v203, s[40:43], s65 offen sc1
    buffer_load_dwordx4 v[224:227], v203, s[40:43], s66 offen sc1
L_w7:
    ds_read_b32 v15, v5 offset:58240
    s_waitcnt lgkmcnt(0)
    v_cmp_gt_i32 vcc, 12, v15
    s_cbranch_vccnz L_w7
    ds_read_b128 v[72:75], v7 offset:0
    ds_read_b128 v[88:91], v7 offset:4096
    v_xor_b32 v15, 64, v7
    ds_read_b128 v[76:79], v15 offset:0
    ds_read_b128 v[92:95], v15 offset:4096
    v_xor_b32 v15, 128, v7
    ds_read_b128 v[80:83], v15 offset:0
    ds_read_b128 v[96:99], v15 offset:4096
    v_xor_b32 v15, 192, v7
    ds_read_b128 v[84:87], v15 offset:0
    ds_read_b128 v[100:103], v15 offset:4096
    s_branch L_att0_in
L_att0:
    buffer_load_dwordx2 v[220:221], v180, s[40:43], s60 offen offset:0 sc1
    buffer_load_dwordx4 v[204:207], v203, s[40:43], s65 offen sc1
    buffer_load_dwordx4 v[224:227], v203, s[40:43], s66 offen sc1
    s_sub_u32 s59, s59, 1
    s_cbranch_scc1 L_giveup
HC6:
H6:
    s_cbranch_execz H5
L_att0_in:
    s_waitcnt vmcnt(0) lgkmcnt(0)
    ds_write_b128 v164, v[204:207]
    ds_write_b128 v164, v[224:227] offset:4096
    v_dot2_f32_bf16 v248, v204, v156, v220
    v_dot2_f32_bf16 v248, v205, v156, v248
    v_dot2_f32_bf16 v248, v206, v156, v248
    v_dot2_f32_bf16 v248, v207, v156, v248
    v_dot2_f32_bf16 v248, v224, v156, v248
    v_dot2_f32_bf16 v248, v225, v156, v248
    v_dot2_f32_bf16 v248, v226, v156, v248
    v_dot2_f32_bf16 v248, v227, v156, v248
    v_add_f32_dpp v220, v220, v220 quad_perm:[1,0,3,2] row_mask:0xf bank_mask:0xf
    v_add_f32_dpp v221, v221, v221 quad_perm:[1,0,3,2] row_mask:0xf bank_mask:0xf
    s_nop 0
    v_cmp_u_f32 vcc, v248, v221
    v_add_f32_dpp v220, v220, v220 quad_perm:[2,3,0,1] row_mask:0xf bank_mask:0xf
    v_add_f32_dpp v221, v221, v221 quad_perm:[2,3,0,1] row_mask:0xf bank_mask:0xf
    s_cbranch_vccnz L_att0
    v_add_f32_dpp v220, v220, v220 row_ror:4 row_mask:0xf bank_mask:0xf
    v_add_f32_dpp v221, v221, v221 row_ror:4 row_mask:0xf bank_mask:0xf
    s_mov_b64 exec, 1
    ds_add_u32 v5, v6 offset:58268
    s_mov_b64 exec, -1
L_w8:
    ds_read_b32 v15, v5 offset:58268
    s_waitcnt lgkmcnt(0)
    v_cmp_gt_i32 vcc, 4, v15
    s_cbranch_vccnz L_w8
    ds_read_b128 v[228:231], v165 offset:4096
    ds_read_b128 v[232:235], v166 offset:4096
    ds_read_b128 v[236:239], v167 offset:4096
    ds_read_b128 v[208:211], v165
    ds_read_b128 v[212:215], v166
    ds_read_b128 v[216:219], v167
    s_waitcnt lgkmcnt(3)
    v_mfma_f32_16x16x32_bf16 v[240:243], v[72:75], v[224:227], 0
    v_mfma_f32_16x16x32_bf16 v[244:247], v[88:91], v[224:227], 0
    v_mfma_f32_16x16x32_bf16 v[240:243], v[76:79], v[228:231], v[240:243]
    v_mfma_f32_16x16x32_bf16 v[244:247], v[92:95], v[228:231], v[244:247]
    v_mfma_f32_16x16x32_bf16 v[240:243], v[80:83], v[232:235], v[240:243]
    v_mfma_f32_16x16x32_bf16 v[244:247], v[96:99], v[232:235], v[244:247]
    v_mfma_f32_16x16x32_bf16 v[240:243], v[84:87], v[236:239], v[240:243]
    v_mfma_f32_16x16x32_bf16 v[244:247], v[100:103], v[236:239], v[244:247]
    s_nop 3
    v_add_f32_dpp v248, v240, v240 row_ror:8 row_mask:0xf bank_mask:0x3
    v_add_f32_dpp v249, v241, v241 row_ror:8 row_mask:0xf bank_mask:0x3
    v_add_f32_dpp v250, v242, v242 row_ror:8 row_mask:0xf bank_mask:0x3
    v_add_f32_dpp v251, v243, v243 row_ror:8 row_mask:0xf bank_mask:0x3
    v_add_f32_dpp v248, v244, v244 row_ror:8 row_mask:0xf bank_mask:0xc
    v_add_f32_dpp v249, v245, v245 row_ror:8 row_mask:0xf bank_mask:0xc
    v_add_f32_dpp v250, v246, v246 row_ror:8 row_mask:0xf bank_mask:0xc
    v_add_f32_dpp v251, v247, v247 row_ror:8 row_mask:0xf bank_mask:0xc
    v_add_f32_dpp v196, v248, v248 row_shl:4 row_mask:0xf bank_mask:0x5
    v_add_f32_dpp v197, v249, v249 row_shl:4 row_mask:0xf bank_mask:0x5
    v_add_f32_dpp v196, v250, v250 row_shr:4 row_mask:0xf bank_mask:0xa
    v_add_f32_dpp v197, v251, v251 row_shr:4 row_mask:0xf bank_mask:0xa
    v_mfma_f32_16x16x32_bf16 v[240:243], v[72:75], v[204:207], 0
    v_mfma_f32_16x16x32_bf16 v[244:247], v[88:91], v[204:207], 0
    v_add_f32_dpp v220, v220, v220 row_ror:8 row_mask:0xf bank_mask:0xf
    v_add_f32_dpp v221, v221, v221 row_ror:8 row_mask:0xf bank_mask:0xf
    v_pk_mul_f32 v[220:221], v[220:221], s[46:47]
    s_waitcnt lgkmcnt(2)
    v_mfma_f32_16x16x32_bf16 v[240:243], v[76:79], v[208:211], v[240:243]
    v_fma_f32 v220, -v221, v221, v220
    v_add_f32 v220, |v220|, s45
    v_mfma_f32_16x16x32_bf16 v[244:247], v[92:95], v[208:211], v[244:247]
    v_rsq_f32 v222, v220
    s_waitcnt lgkmcnt(1)
    v_mfma_f32_16x16x32_bf16 v[240:243], v[80:83], v[212:215], v[240:243]
    v_mul_f32 v222, 0x3e0293ee, v222
    v_mul_f32 v223, v221, v222
    v_mfma_f32_16x16x32_bf16 v[244:247], v[96:99], v[212:215], v[244:247]
    v_pk_mul_f32 v[220:221], v[196:197], v[222:223] op_sel:[0,1] op_sel_hi:[1,1]
    s_waitcnt lgkmcnt(0)
    v_mfma_f32_16x16x32_bf16 v[240:243], v[84:87], v[216:219], v[240:243]
    v_mfma_f32_16x16x32_bf16 v[244:247], v[100:103], v[216:219], v[244:247]
    s_nop 3
    v_add_f32_dpp v248, v240, v240 row_ror:8 row_mask:0xf bank_mask:0x3
    v_add_f32_dpp v249, v241, v241 row_ror:8 row_mask:0xf bank_mask:0x3
    v_add_f32_dpp v250, v242, v242 row_ror:8 row_mask:0xf bank_mask:0x3
    v_add_f32_dpp v251, v243, v243 row_ror:8 row_mask:0xf bank_mask:0x3
    v_add_f32_dpp v248, v244, v244 row_ror:8 row_mask:0xf bank_mask:0xc
    v_add_f32_dpp v249, v245, v245 row_ror:8 row_mask:0xf bank_mask:0xc
    v_add_f32_dpp v250, v246, v246 row_ror:8 row_mask:0xf bank_mask:0xc
    v_add_f32_dpp v251, v247, v247 row_ror:8 row_mask:0xf bank_mask:0xc
    v_add_f32_dpp v252, v248, v248 row_shl:4 row_mask:0xf bank_mask:0x5
    v_add_f32_dpp v253, v249, v249 row_shl:4 row_mask:0xf bank_mask:0x5
    v_add_f32_dpp v252, v250, v250 row_shr:4 row_mask:0xf bank_mask:0xa
    v_add_f32_dpp v253, v251, v251 row_shr:4 row_mask:0xf bank_mask:0xa
    v_pk_fma_f32 v[252:253], v[252:253], v[222:223], v[220:221] op_sel_hi:[1,0,1] neg_lo:[0,0,1] neg_hi:[0,0,1]
    v_exp_f32 v248, v252
    v_exp_f32 v249, v253
    v_max_f32 v254, |v252|, |v253|
    v_cvt_pk_bf16_f32 v248, v248, v249
    ds_write2st64_b32 v191, v248, v5 offset0:0 offset1:4
    v_cmp_lt_f32 vcc, s10, v254
    s_cbranch_vccnz L_sm0_max
L_sm0_done:
    s_mov_b64 exec, 1
    ds_add_u32 v5, v6 offset:58248
    s_mov_b64 exec, -1
L_w9:
    ds_read_b32 v15, v5 offset:58248
    s_waitcnt lgkmcnt(0)
    v_cmp_gt_i32 vcc, 4, v15
    s_cbranch_vccnz L_w9
    s_mov_b32 s65, 0x8000
    s_mov_b32 s60, 0x1000
HC7:
H7:
    s_cbranch_execz H6
L_w10:
    ds_read_b32 v15, v5 offset:58240
    s_waitcnt lgkmcnt(0)
    v_cmp_gt_i32 vcc, 22, v15
    s_cbranch_vccnz L_w10
    ds_read_b64_tr_b16 v[104:105], v8 offset:0
    ds_read_b64_tr_b16 v[106:107], v8 offset:4096
    ds_read_b64_tr_b16 v[108:109], v8 offset:8
    ds_read_b64_tr_b16 v[110:111], v8 offset:4104
    ds_read_b64_tr_b16 v[112:113], v8 offset:8192
    ds_read_b64_tr_b16 v[114:115], v8 offset:12288
    ds_read_b64_tr_b16 v[116:117], v8 offset:8200
    ds_read_b64_tr_b16 v[118:119], v8 offset:12296
    ds_read_b64_tr_b16 v[120:121], v8 offset:16384
    ds_read_b64_tr_b16 v[122:123], v8 offset:20480
    ds_read_b64_tr_b16 v[124:125], v8 offset:16392
    ds_read_b64_tr_b16 v[126:127], v8 offset:20488
    ds_read_b64_tr_b16 v[128:129], v8 offset:24576
    ds_read_b64_tr_b16 v[130:131], v8 offset:28672
    ds_read_b64_tr_b16 v[132:133], v8 offset:24584
    ds_read_b64_tr_b16 v[134:135], v8 offset:28680
    ds_read_b128 v[204:207], v168
    ds_read_b32 v236, v192 offset:1024
    ds_read_b128 v[208:211], v168 offset:256
    ds_read_b128 v[212:215], v169 offset:512
    ds_read_b128 v[216:219], v169 offset:768
    ds_read_b128 v[220:223], v192
    v_mov_b32 v240, 0
    s_waitcnt lgkmcnt(5)
    v_mfma_f32_16x16x32_bf16 v[228:231], v[104:107], v[204:207], 0
    s_waitcnt lgkmcnt(3)
    v_cmp_neq_f32 vcc, 0, v236
    v_mfma_f32_16x16x32_bf16 v[232:235], v[108:111], v[204:207], 0
    v_mfma_f32_16x16x32_bf16 v[228:231], v[112:115], v[208:211], v[228:231]
    s_cbranch_vccnz L_pv0_mix
    v_mfma_f32_16x16x32_bf16 v[232:235], v[116:119], v[208:211], v[232:235]
    s_waitcnt lgkmcnt(0)
    v_mfma_f32_16x16x32_bf16 v[228:231], v[120:123], v[212:215], v[228:231]
    v_mfma_f32_16x16x32_bf16 v[228:231], v[128:131], v[216:219], v[228:231]
    v_mfma_f32_16x16x32_bf16 v[224:227], v[156:159], v[220:223], 0
    v_mfma_f32_16x16x32_bf16 v[232:235], v[124:127], v[212:215], v[232:235]
    v_mfma_f32_16x16x32_bf16 v[232:235], v[132:135], v[216:219], v[232:235]
    v_add_f32_dpp v241, v224, v224 row_ror:4 row_mask:0xf bank_mask:0xf
    v_cvt_pk_bf16_f32 v248, v228, v229
    s_nop 0
    v_add_f32_dpp v241, v241, v241 row_ror:8 row_mask:0xf bank_mask:0xf
    buffer_store_dwordx2 v[240:241], v183, s[40:43], 0 offen offset:0
    s_mov_b64 exec, s[14:15]
    v_cvt_pk_bf16_f32 v248, v230, v231
    s_mov_b64 exec, s[16:17]
    v_cvt_pk_bf16_f32 v248, v232, v233
    s_mov_b64 exec, s[18:19]
    v_cvt_pk_bf16_f32 v248, v234, v235
    s_mov_b64 exec, -1
    buffer_store_dword v248, v182, s[40:43], 0 offen offset:0
L_pv0_done:
HC8:
L_w11:
    ds_read_b32 v15, v5 offset:58240
    s_waitcnt lgkmcnt(0)
    v_cmp_gt_i32 vcc, 27, v15
    s_cbranch_vccnz L_w11
    ds_read_b64_tr_b16 v[32:33], v201 offset:16384
    ds_read_b64_tr_b16 v[34:35], v201 offset:18432
    v_xor_b32 v15, 4096, v201
    ds_read_b64_tr_b16 v[36:37], v15 offset:16384
    ds_read_b64_tr_b16 v[38:39], v15 offset:18432
    v_xor_b32 v15, 8192, v201
    ds_read_b64_tr_b16 v[40:41], v15 offset:16384
    ds_read_b64_tr_b16 v[42:43], v15 offset:18432
    v_xor_b32 v15, 12288, v201
    ds_read_b64_tr_b16 v[44:45], v15 offset:16384
    ds_read_b64_tr_b16 v[46:47], v15 offset:18432
    s_waitcnt vmcnt(0)
L_wo0:
    buffer_load_dwordx2 v[212:213], v185, s[40:43], 0 offen offset:0 sc1
    buffer_load_dwordx4 v[204:207], v184, s[40:43], 0 offen sc1
    buffer_load_dwordx4 v[208:211], v184, s[40:43], 0 offen offset:1024 sc1
    s_sub_u32 s59, s59, 1
    s_cbranch_scc1 L_giveup
HC9:
H9:
    s_cbranch_execz H7
    s_branch PD2
.fill 8, 4, 0xbf800000
PD2:
    s_waitcnt vmcnt(2)
    v_cmp_neq_f32 vcc, 0, v212
    v_add_f32_dpp v239, v213, v213 quad_perm:[1,0,3,2] row_mask:0xf bank_mask:0xf
    s_waitcnt vmcnt(1)
    v_mfma_f32_16x16x32_bf16 v[216:219], v[136:139], v[204:207], 0
    s_cbranch_vccnz L_wo0_chk
    s_waitcnt vmcnt(0)
    v_mfma_f32_16x16x32_bf16 v[216:219], v[136:139], v[208:211], v[216:219]
    v_max_u32 v236, v204, v208
    v_cmp_eq_u32 vcc, -1, v236
    v_add_f32_dpp v239, v239, v239 quad_perm:[2,3,0,1] row_mask:0xf bank_mask:0xf
    s_nop 1
    v_add_f32_dpp v239, v239, v239 row_ror:4 row_mask:0xf bank_mask:0xf
BR2:
    s_cbranch_vccnz L_wo0
    v_add_f32_dpp v237, v216, v216 row_ror:8 row_mask:0xf bank_mask:0x3
    v_add_f32_dpp v238, v217, v217 row_ror:8 row_mask:0xf bank_mask:0x3
    v_add_f32_dpp v237, v218, v218 row_ror:8 row_mask:0xf bank_mask:0xc
    v_add_f32_dpp v238, v219, v219 row_ror:8 row_mask:0xf bank_mask:0xc
    s_nop 0
    v_add_f32_dpp v236, v237, v237 row_shl:4 row_mask:0xf bank_mask:0x5
    v_add_f32_dpp v236, v238, v238 row_shr:4 row_mask:0xf bank_mask:0xa
L_wo0_sum:
    v_cvt_pk_bf16_f32 v237, v236, v236
    ds_write_b16 v188, v237 offset:57856
    v_cmp_u_f32 vcc, v236, v239
    v_add_f32_dpp v236, v239, v239 row_ror:8 row_mask:0xf bank_mask:0xf
    s_cbranch_vccnz L_wo0
    v_mov_b32 v239, v236
    s_waitcnt lgkmcnt(0)
    s_barrier
    ds_read_b32 v15, v5 offset:58256
    ds_read_b128 v[204:207], v190 offset:57856
    v_permlane32_swap_b32 v239, v236
    v_add_f32 v239, v239, v236
    v_rcp_f32 v239, v239
    s_waitcnt lgkmcnt(0)
    v_mfma_f32_16x16x32_bf16 v[208:211], v[204:207], v[32:35], 0
    v_mfma_f32_16x16x32_bf16 v[212:215], v[204:207], v[36:39], 0
    v_mfma_f32_16x16x32_bf16 v[216:219], v[204:207], v[40:43], 0
    v_mfma_f32_16x16x32_bf16 v[220:223], v[204:207], v[44:47], 0
    v_add_f32 v208, v208, v213
    s_nop 2
    v_add_f32 v208, v208, v218
    v_mul_f32 v208, v208, v239
    s_nop 1
    v_fmac_f32 v208, v223, v239
    v_cvt_pk_bf16_f32 v208, s5, v208
    buffer_store_dword v208, v11, s[36:39], 0 offen sc1
    v_readfirstlane_b32 s62, v15
    s_lshr_b32 s9, s52, 1
    s_lshl_b32 s9, s9, 15
    s_add_u32 s9, s9, s62
    s_xor_b32 s6, s9, 0x8000
    s_xor_b32 s7, s9, 0x10000
    s_xor_b32 s8, s9, 0x18000
    v_readfirstlane_b32 s48, v177
    s_nop 0
    s_andn2_b32 s48, s48, 0x2820
    s_mul_i32 s49, s56, s56
    s_lshl_b32 s49, s49, 16
    s_add_u32 s48, s48, s49
    s_add_u32 s48, s48, 0xc0000
    s_cmp_eq_u32 s56, 3
    s_cselect_b32 s48, 0x3ff00000, s48
    v_and_b32 v14, 15, v0
    v_lshlrev_b32 v14, 2, v14
    v_and_b32 v15, 1, v1
    v_lshl_add_u32 v14, v15, 11, v14
    v_lshrrev_b32 v15, 5, v0
    v_lshl_add_u32 v14, v15, 13, v14
    buffer_store_dword v202, v14, s[36:39], s48 offen sc1
    ds_read_b64_tr_b16 v[48:49], v201 offset:32768
    ds_read_b64_tr_b16 v[50:51], v201 offset:34816
    v_xor_b32 v15, 4096, v201
    ds_read_b64_tr_b16 v[52:53], v15 offset:32768
    ds_read_b64_tr_b16 v[54:55], v15 offset:34816
    v_xor_b32 v15, 8192, v201
    ds_read_b64_tr_b16 v[56:57], v15 offset:32768
    ds_read_b64_tr_b16 v[58:59], v15 offset:34816
    v_xor_b32 v15, 12288, v201
    ds_read_b64_tr_b16 v[60:61], v15 offset:32768
    ds_read_b64_tr_b16 v[62:63], v15 offset:34816
    v_and_b32 v15, 0xfff, v201
    ds_read_b64_tr_b16 v[64:65], v15 offset:49152
    ds_read_b64_tr_b16 v[66:67], v15 offset:51200
    ds_read_b64_tr_b16 v[68:69], v15 offset:53248
    ds_read_b64_tr_b16 v[70:71], v15 offset:55296
    s_waitcnt vmcnt(1)
L_su0:
    buffer_load_dwordx4 v[232:235], v10, s[36:39], s6 offen sc1
    buffer_load_dwordx4 v[236:239], v10, s[36:39], s7 offen sc1
    buffer_load_dwordx4 v[240:243], v10, s[36:39], s8 offen sc1
    buffer_load_dwordx4 v[244:247], v10, s[36:39], s9 offen sc1
    s_sub_u32 s59, s59, 1
    s_cbranch_scc1 L_giveup
HC10:
H10:
    s_cbranch_execz L_exit
    s_branch PD3
.fill 11, 4, 0xbf800000
PD3:
L_su0_in:
    s_waitcnt vmcnt(3)
    v_mfma_f32_16x16x32_bf16 v[220:223], v[152:155], v[232:235], 0
    v_bitop3_b32 v226, v232, v233, s4 bitop3:0x7e
    v_bitop3_b32 v227, v234, v235, s4 bitop3:0x7e
    v_or3_b32 v225, v226, v227, 0
    s_waitcnt vmcnt(2)
    v_mfma_f32_16x16x32_bf16 v[220:223], v[152:155], v[236:239], v[220:223]
    v_bitop3_b32 v226, v236, v237, s4 bitop3:0x7e
    v_bitop3_b32 v227, v238, v239, s4 bitop3:0x7e
    v_or3_b32 v225, v226, v227, v225
    s_waitcnt vmcnt(1)
    v_mfma_f32_16x16x32_bf16 v[220:223], v[152:155], v[240:243], v[220:223]
    v_bitop3_b32 v226, v240, v241, s4 bitop3:0x7e
    v_bitop3_b32 v227, v242, v243, s4 bitop3:0x7e
    v_or3_b32 v225, v226, v227, v225
    s_waitcnt vmcnt(0)
    v_mfma_f32_16x16x32_bf16 v[220:223], v[152:155], v[244:247], v[220:223]
    v_bitop3_b32 v226, v244, v245, s4 bitop3:0x7e
    v_bitop3_b32 v227, v246, v247, s4 bitop3:0x7e
    v_or3_b32 v225, v226, v227, v225
    v_cmp_ne_u16 vcc, 0, v225
BR3:
    s_cbranch_vccnz L_su0
    v_add_f32_dpp v224, v220, v220 row_ror:8 row_mask:0xf bank_mask:0x3
    v_add_f32_dpp v224, v221, v221 row_ror:8 row_mask:0xf bank_mask:0xc
    v_cvt_pk_bf16_f32 v224, 0, v224
    v_add_f32 v224, v224, v195
    v_cvt_pk_bf16_f32 v224, 0, v224
    ds_write_b16_d16_hi v4, v224 offset:58880
    v_mul_f32 v228, v224, v224
    v_mov_b32 v229, v224
    s_nop 1
    v_permlane16_swap_b32 v228, v229
    v_add_f32 v228, v228, v229
    v_mov_b32 v195, v224
    s_add_u32 s62, s62, 0x80000
    v_add_f32_dpp v228, v228, v228 quad_perm:[1,0,3,2] row_mask:0xf bank_mask:0xf
    s_waitcnt lgkmcnt(0)
    s_barrier
    ds_read_b128 v[204:207], v189 offset:58880
    v_add_f32_dpp v228, v228, v228 quad_perm:[2,3,0,1] row_mask:0xf bank_mask:0xf
    s_cmp_eq_u32 s55, s56
    s_cselect_b32 s48, 0, 0x3ff00000
    v_add_f32_dpp v228, v228, v228 row_ror:4 row_mask:0xf bank_mask:0xf
    s_nop 1
    v_add_f32_dpp v228, v228, v228 row_ror:8 row_mask:0xf bank_mask:0xf
    buffer_store_dword v228, v181, s[40:43], s48 offen offset:128
    s_waitcnt lgkmcnt(0)
    v_mfma_f32_16x16x32_bf16 v[208:211], v[204:207], v[48:51], 0
    v_mfma_f32_16x16x32_bf16 v[212:215], v[204:207], v[52:55], 0
    v_mfma_f32_16x16x32_bf16 v[216:219], v[204:207], v[56:59], 0
    v_mfma_f32_16x16x32_bf16 v[220:223], v[204:207], v[60:63], 0
    v_add_f32 v208, v208, v213
    s_nop 2
    v_add_f32 v208, v208, v218
    s_nop 2
    v_add_f32 v208, v208, v223
    v_cvt_pk_bf16_f32 v208, v208, v208
    buffer_store_short v208, v186, s[40:43], 0 offen offset:0
    s_mov_b32 s63, 0x80000
    v_cmp_gt_u32 vcc, 16, v0
    v_add_u32 v186, 0x2000, v186
    s_nop 0
    v_cndmask_b32 v186, v13, v186, vcc
    ds_read_u16_d16_hi v195, v188 offset:58880
    s_cmp_eq_u32 s56, 3
    s_cbranch_scc0 L_dn0_b
    s_sleep 2
L_dn0:
    buffer_load_dwordx2 v[244:245], v180, s[40:43], 0 offen offset:128 sc1
    s_sub_u32 s59, s59, 1
    s_cbranch_scc1 L_giveup
HC11:
    s_branch H11
.p2align 12
H11:
    s_cbranch_execz H10
    s_branch PD4
.fill 12, 4, 0xbf800000
PD4:
    s_sleep 1
    buffer_load_dwordx4 v[240:243], v187, s[40:43], 0 offen sc1
    buffer_load_dwordx4 v[248:251], v187, s[40:43], s60 offen sc1
    s_waitcnt vmcnt(2)
    v_add_f32_dpp v212, v244, v244 quad_perm:[1,0,3,2] row_mask:0xf bank_mask:0xf
    v_add_f32_dpp v213, v245, v245 quad_perm:[1,0,3,2] row_mask:0xf bank_mask:0xf
    v_cmp_u_f32 vcc, v244, v245
    v_add_f32_dpp v212, v212, v212 quad_perm:[2,3,0,1] row_mask:0xf bank_mask:0xf
    v_add_f32_dpp v213, v213, v213 quad_perm:[2,3,0,1] row_mask:0xf bank_mask:0xf
    buffer_load_dwordx4 v[240:243], v187, s[40:43], 0 offen sc1
    buffer_load_dwordx4 v[248:251], v187, s[40:43], s60 offen sc1
    v_add_f32_dpp v212, v212, v212 row_ror:4 row_mask:0xf bank_mask:0xf
    v_add_f32_dpp v213, v213, v213 row_ror:4 row_mask:0xf bank_mask:0xf
    s_cbranch_vccnz L_dn0
    v_add_f32_dpp v212, v212, v212 row_ror:8 row_mask:0xf bank_mask:0xf
    v_add_f32_dpp v213, v213, v213 row_ror:8 row_mask:0xf bank_mask:0xf
    v_pk_mul_f32 v[212:213], v[212:213], s[46:47]
    v_fma_f32 v212, -v213, v213, v212
    v_add_f32 v212, |v212|, s45
    v_rsq_f32 v214, v212
    s_nop 0
    v_mul_f32 v215, 0xbfb8aa3b, v214
L_dn0_p:
    s_waitcnt vmcnt(2)
    v_dot2_f32_bf16 v198, v248, v156, 0
    v_dot2_f32_bf16 v199, v250, v156, 0
    v_dot2_f32_bf16 v198, v249, v156, v198
    v_dot2_f32_bf16 v199, v251, v156, v199
    s_nop 2
    v_pk_mul_f32 v[206:207], v[212:213], v[198:199] op_sel:[1,0] neg_lo:[1,0] neg_hi:[1,0]
    v_dot2_f32_bf16 v208, v240, v156, v206
    v_dot2_f32_bf16 v208, v241, v156, v208
    v_dot2_f32_bf16 v209, v242, v156, v207
    v_dot2_f32_bf16 v209, v243, v156, v209
    s_nop 0
    v_mul_f32 v210, v208, v215
    v_exp_f32 v210, v210
    v_cmp_u_f32 vcc, v208, v209
    v_add_f32 v210, 1.0, v210
    v_rcp_f32 v210, v210
    v_pk_mul_f32 v[208:209], v[208:209], v[214:215] op_sel_hi:[1,0]
    v_mul_f32 v208, v208, v210
BR4:
    s_cbranch_vccnz L_dn0_again
    v_mul_f32 v208, v208, v209
    v_cvt_pk_bf16_f32 v210, v208, v208
    ds_write_b16 v193, v210 offset:58368
    s_waitcnt lgkmcnt(0)
L_dn0_b:
    s_barrier
    ds_read_b128 v[216:219], v194 offset:58368
    s_waitcnt lgkmcnt(0)
    v_mfma_f32_16x16x32_bf16 v[220:223], v[216:219], v[64:67], 0
    v_mfma_f32_16x16x32_bf16 v[224:227], v[216:219], v[68:71], 0
    s_nop 7
    v_add_f32 v220, v220, v225
    v_cvt_pk_bf16_f32 v220, v220, v220
    buffer_store_short v220, v177, s[36:39], s63 offen sc1
    buffer_store_dword v202, v182, s[40:43], 0 offen offset:0
    s_or_b32 s48, s2, s56
    s_cselect_b32 s48, 0x3ff00000, 0
    s_add_u32 s48, s48, 0x40000
    v_mov_b32 v15, s57
    buffer_store_dword v15, v5, s[36:39], s48 offen sc1
    s_waitcnt vmcnt(2)
L_sq1:
    buffer_load_dwordx4 v[232:235], v176, s[36:39], s62 offen sc1
    buffer_load_dwordx4 v[236:239], v176, s[36:39], s62 offen offset:1024 sc1
    s_sub_u32 s59, s59, 1
    s_cbranch_scc1 L_giveup
HC12:
H12:
    s_cbranch_execz H11
    s_nop 0
    s_waitcnt vmcnt(1)
    v_mfma_f32_16x16x32_bf16 v[220:223], v[136:139], v[232:235], 0
    s_waitcnt vmcnt(0)
    v_mfma_f32_16x16x32_bf16 v[220:223], v[136:139], v[236:239], v[220:223]
    v_max_u32 v225, v232, v236
    v_cmp_eq_u32 vcc, -1, v225
BR5:
    s_cbranch_vccnz L_sq1
    v_add_f32_dpp v225, v220, v220 row_ror:8 row_mask:0xf bank_mask:0x3
    v_add_f32_dpp v226, v221, v221 row_ror:8 row_mask:0xf bank_mask:0x3
    v_add_f32_dpp v225, v222, v222 row_ror:8 row_mask:0xf bank_mask:0xc
    v_add_f32_dpp v226, v223, v223 row_ror:8 row_mask:0xf bank_mask:0xc
    s_nop 0
    v_add_f32_dpp v224, v225, v225 row_shl:4 row_mask:0xf bank_mask:0x5
    v_add_f32_dpp v224, v226, v226 row_shr:4 row_mask:0xf bank_mask:0xa
    v_cvt_pk_bf16_f32 v224, 0, v224
    v_add_f32 v224, v224, v195
    v_cvt_pk_bf16_f32 v224, 0, v224
    ds_write_b16_d16_hi v188, v224 offset:57344
    v_cmp_u_f32 vcc, v224, v224
    v_mul_f32 v228, v224, v224
    v_mov_b32 v229, v224
    s_nop 1
    v_permlane16_swap_b32 v228, v229
    s_cbranch_vccnz L_sq1
    v_add_f32 v228, v228, v229
    v_mov_b32 v195, v224
    s_add_u32 s62, s62, 0x40000
    v_add_f32_dpp v228, v228, v228 quad_perm:[1,0,3,2] row_mask:0xf bank_mask:0xf
    s_waitcnt lgkmcnt(0)
    s_barrier
    ds_read_b128 v[204:207], v189 offset:57344
    v_add_f32_dpp v228, v228, v228 quad_perm:[2,3,0,1] row_mask:0xf bank_mask:0xf
    s_cmp_eq_u32 s55, s56
    s_cselect_b32 s48, 0, 0x3ff00000
    v_add_f32_dpp v228, v228, v228 row_ror:4 row_mask:0xf bank_mask:0xf
    s_nop 1
    v_add_f32_dpp v228, v228, v228 row_ror:8 row_mask:0xf bank_mask:0xf
    buffer_store_dword v228, v181, s[40:43], s48 offen offset:256
    s_waitcnt lgkmcnt(0)
    v_mfma_f32_16x16x32_bf16 v[208:211], v[204:207], v[16:19], 0
    v_mfma_f32_16x16x32_bf16 v[212:215], v[204:207], v[20:23], 0
    v_mfma_f32_16x16x32_bf16 v[216:219], v[204:207], v[24:27], 0
    v_mfma_f32_16x16x32_bf16 v[220:223], v[204:207], v[28:31], 0
    v_add_f32 v208, v208, v213
    s_nop 2
    v_add_f32 v208, v208, v218
    s_nop 2
    v_add_f32 v208, v208, v223
    v_cvt_pk_bf16_f32 v208, v208, v208
    buffer_store_short v208, v178, s[40:43], 0 offen offset:0
    s_mov_b32 s63, 0xc0000
    s_sleep 1
L_att1:
    buffer_load_dwordx2 v[250:251], v180, s[40:43], 0 offen offset:256 sc1
    s_sub_u32 s59, s59, 1
    s_cbranch_scc1 L_giveup
HC13:
H13:
    s_cbranch_execz H12
    s_waitcnt vmcnt(1)
    buffer_load_dwordx4 v[204:207], v203, s[40:43], s65 offen sc1
    s_waitcnt vmcnt(1)
    v_add_f32_dpp v220, v250, v250 quad_perm:[1,0,3,2] row_mask:0xf bank_mask:0xf
    v_add_f32_dpp v221, v251, v251 quad_perm:[1,0,3,2] row_mask:0xf bank_mask:0xf
    v_cmp_u_f32 vcc, v250, v251
    v_add_f32_dpp v220, v220, v220 quad_perm:[2,3,0,1] row_mask:0xf bank_mask:0xf
    v_add_f32_dpp v221, v221, v221 quad_perm:[2,3,0,1] row_mask:0xf bank_mask:0xf
    s_nop 0
    v_add_f32_dpp v220, v220, v220 row_ror:4 row_mask:0xf bank_mask:0xf
    v_add_f32_dpp v221, v221, v221 row_ror:4 row_mask:0xf bank_mask:0xf
    s_cbranch_vccnz L_att1
    v_add_f32_dpp v220, v220, v220 row_ror:8 row_mask:0xf bank_mask:0xf
    v_add_f32_dpp v221, v221, v221 row_ror:8 row_mask:0xf bank_mask:0xf
    v_pk_mul_f32 v[220:221], v[220:221], s[46:47]
    v_fma_f32 v220, -v221, v221, v220
    v_add_f32 v220, |v220|, s45
    v_rsq_f32 v222, v220
    s_nop 0
    v_mul_f32 v222, 0x3e0293ee, v222
    v_mul_f32 v223, v221, v222
    v_pk_mul_f32 v[220:221], v[196:197], v[222:223] op_sel:[0,1] op_sel_hi:[1,1]
L_att1_q:
    s_waitcnt vmcnt(0)
    ds_write_b128 v164, v[204:207]
    v_dot2_f32_bf16 v248, v204, v156, 0
    v_dot2_f32_bf16 v248, v205, v156, v248
    v_dot2_f32_bf16 v248, v206, v156, v248
    v_dot2_f32_bf16 v248, v207, v156, v248
    v_mfma_f32_16x16x32_bf16 v[240:243], v[72:75], v[204:207], 0
    s_nop 1
    v_cmp_u_f32 vcc, v248, v248
    v_mfma_f32_16x16x32_bf16 v[244:247], v[88:91], v[204:207], 0
BR6:
    s_cbranch_vccnz L_att1_again
    s_waitcnt lgkmcnt(0)
    s_barrier
    ds_read_b128 v[208:211], v165
    ds_read_b128 v[212:215], v166
    ds_read_b128 v[216:219], v167
    s_waitcnt lgkmcnt(2)
    v_mfma_f32_16x16x32_bf16 v[240:243], v[76:79], v[208:211], v[240:243]
    v_mfma_f32_16x16x32_bf16 v[244:247], v[92:95], v[208:211], v[244:247]
    s_waitcnt lgkmcnt(1)
    v_mfma_f32_16x16x32_bf16 v[240:243], v[80:83], v[212:215], v[240:243]
    v_mfma_f32_16x16x32_bf16 v[244:247], v[96:99], v[212:215], v[244:247]
    s_waitcnt lgkmcnt(0)
    v_mfma_f32_16x16x32_bf16 v[240:243], v[84:87], v[216:219], v[240:243]
    v_mfma_f32_16x16x32_bf16 v[244:247], v[100:103], v[216:219], v[244:247]
    s_nop 3
    v_add_f32_dpp v248, v240, v240 row_ror:8 row_mask:0xf bank_mask:0x3
    v_add_f32_dpp v249, v241, v241 row_ror:8 row_mask:0xf bank_mask:0x3
    v_add_f32_dpp v250, v242, v242 row_ror:8 row_mask:0xf bank_mask:0x3
    v_add_f32_dpp v251, v243, v243 row_ror:8 row_mask:0xf bank_mask:0x3
    v_add_f32_dpp v248, v244, v244 row_ror:8 row_mask:0xf bank_mask:0xc
    v_add_f32_dpp v249, v245, v245 row_ror:8 row_mask:0xf bank_mask:0xc
    v_add_f32_dpp v250, v246, v246 row_ror:8 row_mask:0xf bank_mask:0xc
    v_add_f32_dpp v251, v247, v247 row_ror:8 row_mask:0xf bank_mask:0xc
    v_add_f32_dpp v252, v248, v248 row_shl:4 row_mask:0xf bank_mask:0x5
    v_add_f32_dpp v253, v249, v249 row_shl:4 row_mask:0xf bank_mask:0x5
    v_add_f32_dpp v252, v250, v250 row_shr:4 row_mask:0xf bank_mask:0xa
    v_add_f32_dpp v253, v251, v251 row_shr:4 row_mask:0xf bank_mask:0xa
    v_pk_fma_f32 v[252:253], v[252:253], v[222:223], v[220:221] op_sel_hi:[1,0,1] neg_lo:[0,0,1] neg_hi:[0,0,1]
    v_exp_f32 v248, v252
    v_exp_f32 v249, v253
    v_max_f32 v254, |v252|, |v253|
    v_cvt_pk_bf16_f32 v248, v248, v249
    ds_write2st64_b32 v191, v248, v5 offset0:0 offset1:4
    v_cmp_lt_f32 vcc, s10, v254
    s_cbranch_vccnz L_sm1_max
L_sm1_done:
    s_waitcnt lgkmcnt(0)
    s_barrier
    ds_read_b128 v[204:207], v168
    ds_read_b32 v236, v192 offset:1024
    ds_read_b128 v[208:211], v168 offset:256
    ds_read_b128 v[212:215], v169 offset:512
    ds_read_b128 v[216:219], v169 offset:768
    ds_read_b128 v[220:223], v192
    v_mov_b32 v240, 0
    s_waitcnt lgkmcnt(5)
    v_mfma_f32_16x16x32_bf16 v[228:231], v[104:107], v[204:207], 0
    s_waitcnt lgkmcnt(3)
    v_cmp_neq_f32 vcc, 0, v236
    v_mfma_f32_16x16x32_bf16 v[232:235], v[108:111], v[204:207], 0
    v_mfma_f32_16x16x32_bf16 v[228:231], v[112:115], v[208:211], v[228:231]
    s_cbranch_vccnz L_pv1_mix
    v_mfma_f32_16x16x32_bf16 v[232:235], v[116:119], v[208:211], v[232:235]
    s_waitcnt lgkmcnt(0)
    v_mfma_f32_16x16x32_bf16 v[228:231], v[120:123], v[212:215], v[228:231]
    v_mfma_f32_16x16x32_bf16 v[228:231], v[128:131], v[216:219], v[228:231]
    v_mfma_f32_16x16x32_bf16 v[224:227], v[156:159], v[220:223], 0
    v_mfma_f32_16x16x32_bf16 v[232:235], v[124:127], v[212:215], v[232:235]
    v_mfma_f32_16x16x32_bf16 v[232:235], v[132:135], v[216:219], v[232:235]
    v_add_f32_dpp v241, v224, v224 row_ror:4 row_mask:0xf bank_mask:0xf
    v_cvt_pk_bf16_f32 v248, v228, v229
    s_nop 0
    v_add_f32_dpp v241, v241, v241 row_ror:8 row_mask:0xf bank_mask:0xf
    buffer_store_dwordx2 v[240:241], v183, s[40:43], 0 offen offset:1024
    s_mov_b64 exec, s[14:15]
    v_cvt_pk_bf16_f32 v248, v230, v231
    s_mov_b64 exec, s[16:17]
    v_cvt_pk_bf16_f32 v248, v232, v233
    s_mov_b64 exec, s[18:19]
    v_cvt_pk_bf16_f32 v248, v234, v235
    s_mov_b64 exec, -1
    buffer_store_dword v248, v182, s[40:43], 0 offen offset:0
L_pv1_done:
    s_waitcnt vmcnt(0)
L_wo1:
    buffer_load_dwordx2 v[212:213], v185, s[40:43], 0 offen offset:1024 sc1
    buffer_load_dwordx4 v[204:207], v184, s[40:43], 0 offen sc1
    buffer_load_dwordx4 v[208:211], v184, s[40:43], 0 offen offset:1024 sc1
    s_sub_u32 s59, s59, 1
    s_cbranch_scc1 L_giveup
HC14:
H14:
    s_cbranch_execz H13
    s_branch PD7
.fill 11, 4, 0xbf800000
PD7:
    s_waitcnt vmcnt(2)
    v_cmp_neq_f32 vcc, 0, v212
    v_add_f32_dpp v239, v213, v213 quad_perm:[1,0,3,2] row_mask:0xf bank_mask:0xf
    s_waitcnt vmcnt(1)
    v_mfma_f32_16x16x32_bf16 v[216:219], v[136:139], v[204:207], 0
    s_cbranch_vccnz L_wo1_chk
    s_waitcnt vmcnt(0)
    v_mfma_f32_16x16x32_bf16 v[216:219], v[136:139], v[208:211], v[216:219]
    v_max_u32 v236, v204, v208
    v_cmp_eq_u32 vcc, -1, v236
    v_add_f32_dpp v239, v239, v239 quad_perm:[2,3,0,1] row_mask:0xf bank_mask:0xf
    s_nop 1
    v_add_f32_dpp v239, v239, v239 row_ror:4 row_mask:0xf bank_mask:0xf
BR7:
    s_cbranch_vccnz L_wo1
    v_add_f32_dpp v237, v216, v216 row_ror:8 row_mask:0xf bank_mask:0x3
    v_add_f32_dpp v238, v217, v217 row_ror:8 row_mask:0xf bank_mask:0x3
    v_add_f32_dpp v237, v218, v218 row_ror:8 row_mask:0xf bank_mask:0xc
    v_add_f32_dpp v238, v219, v219 row_ror:8 row_mask:0xf bank_mask:0xc
    s_nop 0
    v_add_f32_dpp v236, v237, v237 row_shl:4 row_mask:0xf bank_mask:0x5
    v_add_f32_dpp v236, v238, v238 row_shr:4 row_mask:0xf bank_mask:0xa
L_wo1_sum:
    v_cvt_pk_bf16_f32 v237, v236, v236
    ds_write_b16 v188, v237 offset:57856
    v_cmp_u_f32 vcc, v236, v239
    v_add_f32_dpp v236, v239, v239 row_ror:8 row_mask:0xf bank_mask:0xf
    s_cbranch_vccnz L_wo1
    v_mov_b32 v239, v236
    s_waitcnt lgkmcnt(0)
    s_barrier
    ds_read_b128 v[204:207], v190 offset:57856
    v_permlane32_swap_b32 v239, v236
    v_add_f32 v239, v239, v236
    v_rcp_f32 v239, v239
    s_waitcnt lgkmcnt(0)
    v_mfma_f32_16x16x32_bf16 v[208:211], v[204:207], v[32:35], 0
    v_mfma_f32_16x16x32_bf16 v[212:215], v[204:207], v[36:39], 0
    v_mfma_f32_16x16x32_bf16 v[216:219], v[204:207], v[40:43], 0
    v_mfma_f32_16x16x32_bf16 v[220:223], v[204:207], v[44:47], 0
    v_add_f32 v208, v208, v213
    s_nop 2
    v_add_f32 v208, v208, v218
    v_mul_f32 v208, v208, v239
    s_nop 1
    v_fmac_f32 v208, v223, v239
    v_cvt_pk_bf16_f32 v208, v208, v208
    buffer_store_short v208, v177, s[36:39], s63 offen sc1
    s_waitcnt vmcnt(0)
L_su1:
    buffer_load_dwordx4 v[232:235], v176, s[36:39], s62 offen sc1
    buffer_load_dwordx4 v[236:239], v176, s[36:39], s62 offen offset:1024 sc1
    s_sub_u32 s59, s59, 1
    s_cbranch_scc1 L_giveup
HC15:
H15:
    s_cbranch_execz H14
    s_branch PD8
.fill 14, 4, 0xbf800000
PD8:
    s_waitcnt vmcnt(1)
    v_mfma_f32_16x16x32_bf16 v[220:223], v[136:139], v[232:235], 0
    s_waitcnt vmcnt(0)
    v_mfma_f32_16x16x32_bf16 v[220:223], v[136:139], v[236:239], v[220:223]
    v_max_u32 v225, v232, v236
    v_cmp_eq_u32 vcc, -1, v225
BR8:
    s_cbranch_vccnz L_su1
    v_add_f32_dpp v225, v220, v220 row_ror:8 row_mask:0xf bank_mask:0x3
    v_add_f32_dpp v226, v221, v221 row_ror:8 row_mask:0xf bank_mask:0x3
    v_add_f32_dpp v225, v222, v222 row_ror:8 row_mask:0xf bank_mask:0xc
    v_add_f32_dpp v226, v223, v223 row_ror:8 row_mask:0xf bank_mask:0xc
    s_nop 0
    v_add_f32_dpp v224, v225, v225 row_shl:4 row_mask:0xf bank_mask:0x5
    v_add_f32_dpp v224, v226, v226 row_shr:4 row_mask:0xf bank_mask:0xa
    v_cvt_pk_bf16_f32 v224, 0, v224
    v_add_f32 v224, v224, v195
    v_cvt_pk_bf16_f32 v224, 0, v224
    ds_write_b16_d16_hi v188, v224 offset:58880
    v_cmp_u_f32 vcc, v224, v224
    v_mul_f32 v228, v224, v224
    v_mov_b32 v229, v224
    s_nop 1
    v_permlane16_swap_b32 v228, v229
    s_cbranch_vccnz L_su1
    v_add_f32 v228, v228, v229
    v_mov_b32 v195, v224
    s_add_u32 s62, s62, 0x40000
    v_add_f32_dpp v228, v228, v228 quad_perm:[1,0,3,2] row_mask:0xf bank_mask:0xf
    s_waitcnt lgkmcnt(0)
    s_barrier
    ds_read_b128 v[204:207], v189 offset:58880
    v_add_f32_dpp v228, v228, v228 quad_perm:[2,3,0,1] row_mask:0xf bank_mask:0xf
    s_cmp_eq_u32 s55, s56
    s_cselect_b32 s48, 0, 0x3ff00000
    v_add_f32_dpp v228, v228, v228 row_ror:4 row_mask:0xf bank_mask:0xf
    s_nop 1
    v_add_f32_dpp v228, v228, v228 row_ror:8 row_mask:0xf bank_mask:0xf
    buffer_store_dword v228, v181, s[40:43], s48 offen offset:384
    s_waitcnt lgkmcnt(0)
    v_mfma_f32_16x16x32_bf16 v[208:211], v[204:207], v[48:51], 0
    v_mfma_f32_16x16x32_bf16 v[212:215], v[204:207], v[52:55], 0
    v_mfma_f32_16x16x32_bf16 v[216:219], v[204:207], v[56:59], 0
    v_mfma_f32_16x16x32_bf16 v[220:223], v[204:207], v[60:63], 0
    v_add_f32 v208, v208, v213
    s_nop 2
    v_add_f32 v208, v208, v218
    s_nop 2
    v_add_f32 v208, v208, v223
    v_cvt_pk_bf16_f32 v208, v208, v208
    buffer_store_short v208, v186, s[40:43], 0 offen offset:0
    s_mov_b32 s63, 0x100000
    v_and_b32 v14, 16, v0
    v_cmp_eq_u32 vcc, 0, v14
    s_nop 1
    v_cndmask_b32 v177, v13, v177, vcc
    s_cmp_eq_u32 s56, 3
    s_cbranch_scc0 L_dn1_b
    s_sleep 2
L_dn1:
    buffer_load_dwordx2 v[244:245], v180, s[40:43], 0 offen offset:384 sc1
    s_sub_u32 s59, s59, 1
    s_cbranch_scc1 L_giveup
HC16:
H16:
    s_cbranch_execz H15
    s_branch PD9
.fill 9, 4, 0xbf800000
PD9:
    s_sleep 1
    buffer_load_dwordx4 v[240:243], v187, s[40:43], s64 offen sc1
    s_waitcnt vmcnt(1)
    v_add_f32_dpp v212, v244, v244 quad_perm:[1,0,3,2] row_mask:0xf bank_mask:0xf
    v_add_f32_dpp v213, v245, v245 quad_perm:[1,0,3,2] row_mask:0xf bank_mask:0xf
    v_cmp_u_f32 vcc, v244, v245
    v_add_f32_dpp v212, v212, v212 quad_perm:[2,3,0,1] row_mask:0xf bank_mask:0xf
    v_add_f32_dpp v213, v213, v213 quad_perm:[2,3,0,1] row_mask:0xf bank_mask:0xf
    buffer_load_dwordx4 v[240:243], v187, s[40:43], s64 offen sc1
    v_add_f32_dpp v212, v212, v212 row_ror:4 row_mask:0xf bank_mask:0xf
    v_add_f32_dpp v213, v213, v213 row_ror:4 row_mask:0xf bank_mask:0xf
    s_cbranch_vccnz L_dn1
    v_add_f32_dpp v212, v212, v212 row_ror:8 row_mask:0xf bank_mask:0xf
    v_add_f32_dpp v213, v213, v213 row_ror:8 row_mask:0xf bank_mask:0xf
    v_pk_mul_f32 v[212:213], v[212:213], s[46:47]
    v_fma_f32 v212, -v213, v213, v212
    v_add_f32 v212, |v212|, s45
    v_rsq_f32 v214, v212
    v_pk_mul_f32 v[206:207], v[212:213], v[198:199] op_sel:[1,0] neg_lo:[1,0] neg_hi:[1,0]
    v_mul_f32 v215, 0xbfb8aa3b, v214
L_dn1_p:
    s_waitcnt vmcnt(1)
    v_dot2_f32_bf16 v208, v240, v156, v206
    v_dot2_f32_bf16 v208, v241, v156, v208
    v_dot2_f32_bf16 v209, v242, v156, v207
    v_dot2_f32_bf16 v209, v243, v156, v209
    s_nop 0
    v_mul_f32 v210, v208, v215
    v_exp_f32 v210, v210
    v_cmp_u_f32 vcc, v208, v209
    v_add_f32 v210, 1.0, v210
    v_rcp_f32 v210, v210
    v_pk_mul_f32 v[208:209], v[208:209], v[214:215] op_sel_hi:[1,0]
    v_mul_f32 v208, v208, v210
BR9:
    s_cbranch_vccnz L_dn1_again
    v_mul_f32 v208, v208, v209
    v_cvt_pk_bf16_f32 v210, v208, v208
    ds_write_b16 v193, v210 offset:58368
    s_waitcnt lgkmcnt(0)
L_dn1_b:
    s_barrier
    ds_read_b128 v[216:219], v194 offset:58368
    s_waitcnt lgkmcnt(0)
    v_mfma_f32_16x16x32_bf16 v[220:223], v[216:219], v[64:67], 0
    v_mfma_f32_16x16x32_bf16 v[224:227], v[216:219], v[68:71], 0
    s_nop 7
    v_add_f32 v220, v220, v225
    v_cvt_pk_bf16_f32 v220, v220, v220
    buffer_store_short v220, v177, s[36:39], s63 offen sc1
L_last:
    s_xor_b32 s48, s55, s56
    s_or_b32 s48, s48, s52
    s_cbranch_scc1 L_fin
    s_sleep 9
L_sf:
    buffer_load_dwordx4 v[232:235], v176, s[36:39], s62 offen sc1
    buffer_load_dwordx4 v[236:239], v176, s[36:39], s62 offen offset:1024 sc1
    s_sub_u32 s59, s59, 1
    s_cbranch_scc1 L_giveup
HC17:
    s_branch PD10
.fill 8, 4, 0xbf800000
PD10:
    s_waitcnt vmcnt(1)
    v_mfma_f32_16x16x32_bf16 v[220:223], v[136:139], v[232:235], 0
    s_waitcnt vmcnt(0)
    v_mfma_f32_16x16x32_bf16 v[220:223], v[136:139], v[236:239], v[220:223]
    v_max_u32 v225, v232, v236
    v_cmp_eq_u32 vcc, -1, v225
BR10:
    s_cbranch_vccnz L_sf
    v_add_f32_dpp v225, v220, v220 row_ror:8 row_mask:0xf bank_mask:0x3
    v_add_f32_dpp v226, v221, v221 row_ror:8 row_mask:0xf bank_mask:0x3
    v_add_f32_dpp v225, v222, v222 row_ror:8 row_mask:0xf bank_mask:0xc
    v_add_f32_dpp v226, v223, v223 row_ror:8 row_mask:0xf bank_mask:0xc
    s_nop 0
    v_add_f32_dpp v224, v225, v225 row_shl:4 row_mask:0xf bank_mask:0x5
    v_add_f32_dpp v224, v226, v226 row_shr:4 row_mask:0xf bank_mask:0xa
    v_cvt_pk_bf16_f32 v224, 0, v224
    v_add_f32 v224, v224, v195
    v_cvt_pk_bf16_f32 v224, 0, v224
    buffer_store_short_d16_hi v224, v200, s[28:31], 0 offen
    v_cmp_u_f32 vcc, v224, v224
    s_cbranch_vccnz L_sf
L_fin:
    s_endpgm
L_wo0_chk:
    v_cmp_u_f32 vcc, v212, v213
    s_cbranch_vccnz L_wo0
    s_branch L_wo0_mix
L_dn0_again:
    buffer_load_dwordx4 v[240:243], v187, s[40:43], 0 offen sc1
    buffer_load_dwordx4 v[248:251], v187, s[40:43], s60 offen sc1
    s_sub_u32 s59, s59, 1
    s_cbranch_scc1 L_giveup
    s_branch L_dn0_p
L_att1_again:
    buffer_load_dwordx4 v[204:207], v203, s[40:43], s65 offen sc1
    s_sub_u32 s59, s59, 1
    s_cbranch_scc1 L_giveup
    s_branch L_att1_q
L_wo1_chk:
    v_cmp_u_f32 vcc, v212, v213
    s_cbranch_vccnz L_wo1
    s_branch L_wo1_mix
L_dn1_again:
    buffer_load_dwordx4 v[240:243], v187, s[40:43], s64 offen sc1
    s_sub_u32 s59, s59, 1
    s_cbranch_scc1 L_giveup
    s_branch L_dn1_p
L_hotend:
L_giveup:
    s_waitcnt vmcnt(0)
    s_or_b32 s48, s2, s56
    s_cselect_b32 s48, 0x3ff00000, 0
    s_add_u32 s48, s48, 0x40000
    v_mov_b32 v15, s57
    buffer_store_dword v15, v5, s[36:39], s48 offen sc1
    ds_add_u32 v5, v6 offset:58248
    ds_add_u32 v5, v6 offset:58252
    ds_add_u32 v5, v6 offset:58268
    s_xor_b32 s48, s55, s56
    s_or_b32 s48, s48, s52
    s_cbranch_scc1 L_fin
    buffer_store_short v202, v200, s[28:31], 0 offen
    s_branch L_fin
L_hvec:
    v_and_b32 v13, 31, v0
    v_lshlrev_b32 v14, 2, v13
    v_lshlrev_b32 v15, 7, v13
    v_mov_b32 v16, s42
    s_mov_b64 exec, 1
    buffer_store_dword v16, v5, s[36:39], s63 offen sc1
    s_mov_b64 exec, -1
L_hvec1:
    buffer_load_dword v17, v14, s[36:39], s64 offen sc1
    buffer_load_dword v18, v15, s[36:39], s62 offen sc1
    v_mov_b32 v13, 1
    s_sub_u32 s59, s59, 1
    s_cbranch_scc1 L_hsig
    s_waitcnt vmcnt(0)
    v_and_b32 v17, 0xffffffe7, v17
    v_mov_b32 v13, 0x10001
    v_cmp_ne_u32 vcc, s42, v17
    s_cbranch_vccz L_hsig
    v_xor_b32 v19, s57, v18
    v_cmp_lt_u32 vcc, 7, v19
    s_cbranch_vccnz L_hvec1
    v_cmp_ne_u32 vcc, s42, v18
    s_cbranch_vccz L_hvec1
    s_add_u32 s65, s65, 0x100000
    s_add_u32 s61, s61, 0x100000
    s_mov_b64 exec, s[50:51]
    buffer_store_dwordx4 v[8:11], v3, s[36:39], s61 offen sc1
    s_mov_b64 exec, -1
    buffer_store_dwordx4 v[8:11], v179, s[36:39], s65 offen offset:0 sc1
    buffer_store_dwordx4 v[8:11], v179, s[36:39], s65 offen offset:1024 sc1
    v_mov_b32 v16, s57
    v_mov_b32 v13, 1
    s_waitcnt vmcnt(0)
    s_mov_b64 exec, 1
    buffer_store_dword v16, v5, s[36:39], s63 offen offset:4 sc1
    s_mov_b64 exec, -1
L_hvec2:
    buffer_load_dword v18, v15, s[36:39], s62 offen offset:4 sc1
    s_sub_u32 s59, s59, 1
    s_cbranch_scc1 L_hsig
    s_waitcnt vmcnt(0)
    v_cmp_ne_u32 vcc, s57, v18
    s_cbranch_vccnz L_hvec2
L_hsig:
    s_mov_b64 exec, 1
    ds_add_u32 v5, v13 offset:58244
    s_branch L_hok
L_slow:
    s_add_u32 s40, s40, 0x100000
    s_addc_u32 s41, s41, 0
    s_mov_b32 s45, 0x3727c5ac
    ds_read_b128 v[204:207], v189 offset:57344
    v_mul_f32 v228, v195, v195
    s_cmp_eq_u32 s55, 0
    s_cselect_b32 s48, s60, 0x3ff00000
    v_mov_b32 v229, v195
    s_nop 1
    v_permlane16_swap_b32 v228, v229
    v_add_f32 v228, v228, v229
    s_nop 1
    v_add_f32_dpp v228, v228, v228 quad_perm:[1,0,3,2] row_mask:0xf bank_mask:0xf
    s_nop 1
    v_add_f32_dpp v228, v228, v228 quad_perm:[2,3,0,1] row_mask:0xf bank_mask:0xf
    s_nop 1
    v_add_f32_dpp v228, v228, v228 row_ror:4 row_mask:0xf bank_mask:0xf
    s_nop 1
    v_add_f32_dpp v228, v228, v228 row_ror:8 row_mask:0xf bank_mask:0xf
    buffer_store_dword v228, v181, s[40:43], s48 offen offset:0 sc1
    s_waitcnt lgkmcnt(0)
    v_mfma_f32_16x16x32_bf16 v[208:211], v[204:207], v[16:19], 0
    v_mfma_f32_16x16x32_bf16 v[212:215], v[204:207], v[20:23], 0
    v_mfma_f32_16x16x32_bf16 v[216:219], v[204:207], v[24:27], 0
    v_mfma_f32_16x16x32_bf16 v[220:223], v[204:207], v[28:31], 0
    v_add_f32 v208, v208, v213
    s_nop 2
    v_add_f32 v208, v208, v218
    s_nop 2
    v_add_f32 v208, v208, v223
    v_cvt_pk_bf16_f32 v208, v208, v208
    buffer_store_short v208, v178, s[40:43], 0 offen offset:0 sc1
    v_cmp_gt_u32 vcc, 16, v0
    v_subrev_u32 v178, 0x8000, v178
    s_nop 0
    v_cndmask_b32 v178, v13, v178, vcc
    s_waitcnt vmcnt(0)
    buffer_load_dwordx2 v[220:221], v180, s[40:43], s60 offen offset:0 sc1
    buffer_load_dwordx4 v[204:207], v203, s[40:43], s65 offen sc1
    buffer_load_dwordx4 v[224:227], v203, s[40:43], s66 offen sc1
L_w12:
    ds_read_b32 v15, v5 offset:58240
    s_waitcnt lgkmcnt(0)
    v_cmp_gt_i32 vcc, 12, v15
    s_cbranch_vccnz L_w12
    ds_read_b128 v[72:75], v7 offset:0
    ds_read_b128 v[88:91], v7 offset:4096
    v_xor_b32 v15, 64, v7
    ds_read_b128 v[76:79], v15 offset:0
    ds_read_b128 v[92:95], v15 offset:4096
    v_xor_b32 v15, 128, v7
    ds_read_b128 v[80:83], v15 offset:0
    ds_read_b128 v[96:99], v15 offset:4096
    v_xor_b32 v15, 192, v7
    ds_read_b128 v[84:87], v15 offset:0
    ds_read_b128 v[100:103], v15 offset:4096
    s_branch L_att0_ins
L_att0s:
    buffer_load_dwordx2 v[220:221], v180, s[40:43], s60 offen offset:0 sc1
    buffer_load_dwordx4 v[204:207], v203, s[40:43], s65 offen sc1
    buffer_load_dwordx4 v[224:227], v203, s[40:43], s66 offen sc1
    s_sub_u32 s59, s59, 1
    s_cbranch_scc1 L_giveup
L_att0_ins:
    s_waitcnt vmcnt(0) lgkmcnt(0)
    ds_write_b128 v164, v[204:207]
    ds_write_b128 v164, v[224:227] offset:4096
    v_dot2_f32_bf16 v248, v204, v156, v220
    v_dot2_f32_bf16 v248, v205, v156, v248
    v_dot2_f32_bf16 v248, v206, v156, v248
    v_dot2_f32_bf16 v248, v207, v156, v248
    v_dot2_f32_bf16 v248, v224, v156, v248
    v_dot2_f32_bf16 v248, v225, v156, v248
    v_dot2_f32_bf16 v248, v226, v156, v248
    v_dot2_f32_bf16 v248, v227, v156, v248
    v_add_f32_dpp v220, v220, v220 quad_perm:[1,0,3,2] row_mask:0xf bank_mask:0xf
    v_add_f32_dpp v221, v221, v221 quad_perm:[1,0,3,2] row_mask:0xf bank_mask:0xf
    s_nop 0
    v_cmp_u_f32 vcc, v248, v221
    v_add_f32_dpp v220, v220, v220 quad_perm:[2,3,0,1] row_mask:0xf bank_mask:0xf
    v_add_f32_dpp v221, v221, v221 quad_perm:[2,3,0,1] row_mask:0xf bank_mask:0xf
    s_cbranch_vccnz L_att0s
    v_add_f32_dpp v220, v220, v220 row_ror:4 row_mask:0xf bank_mask:0xf
    v_add_f32_dpp v221, v221, v221 row_ror:4 row_mask:0xf bank_mask:0xf
    s_mov_b64 exec, 1
    ds_add_u32 v5, v6 offset:58268
    s_mov_b64 exec, -1
L_w13:
    ds_read_b32 v15, v5 offset:58268
    s_waitcnt lgkmcnt(0)
    v_cmp_gt_i32 vcc, 4, v15
    s_cbranch_vccnz L_w13
    ds_read_b128 v[228:231], v165 offset:4096
    ds_read_b128 v[232:235], v166 offset:4096
    ds_read_b128 v[236:239], v167 offset:4096
    ds_read_b128 v[208:211], v165
    ds_read_b128 v[212:215], v166
    ds_read_b128 v[216:219], v167
    s_waitcnt lgkmcnt(3)
    v_mfma_f32_16x16x32_bf16 v[240:243], v[72:75], v[224:227], 0
    v_mfma_f32_16x16x32_bf16 v[244:247], v[88:91], v[224:227], 0
    v_mfma_f32_16x16x32_bf16 v[240:243], v[76:79], v[228:231], v[240:243]
    v_mfma_f32_16x16x32_bf16 v[244:247], v[92:95], v[228:231], v[244:247]
    v_mfma_f32_16x16x32_bf16 v[240:243], v[80:83], v[232:235], v[240:243]
    v_mfma_f32_16x16x32_bf16 v[244:247], v[96:99], v[232:235], v[244:247]
    v_mfma_f32_16x16x32_bf16 v[240:243], v[84:87], v[236:239], v[240:243]
    v_mfma_f32_16x16x32_bf16 v[244:247], v[100:103], v[236:239], v[244:247]
    s_nop 3
    v_add_f32_dpp v248, v240, v240 row_ror:8 row_mask:0xf bank_mask:0x3
    v_add_f32_dpp v249, v241, v241 row_ror:8 row_mask:0xf bank_mask:0x3
    v_add_f32_dpp v250, v242, v242 row_ror:8 row_mask:0xf bank_mask:0x3
    v_add_f32_dpp v251, v243, v243 row_ror:8 row_mask:0xf bank_mask:0x3
    v_add_f32_dpp v248, v244, v244 row_ror:8 row_mask:0xf bank_mask:0xc
    v_add_f32_dpp v249, v245, v245 row_ror:8 row_mask:0xf bank_mask:0xc
    v_add_f32_dpp v250, v246, v246 row_ror:8 row_mask:0xf bank_mask:0xc
    v_add_f32_dpp v251, v247, v247 row_ror:8 row_mask:0xf bank_mask:0xc
    v_add_f32_dpp v196, v248, v248 row_shl:4 row_mask:0xf bank_mask:0x5
    v_add_f32_dpp v197, v249, v249 row_shl:4 row_mask:0xf bank_mask:0x5
    v_add_f32_dpp v196, v250, v250 row_shr:4 row_mask:0xf bank_mask:0xa
    v_add_f32_dpp v197, v251, v251 row_shr:4 row_mask:0xf bank_mask:0xa
    v_mfma_f32_16x16x32_bf16 v[240:243], v[72:75], v[204:207], 0
    v_mfma_f32_16x16x32_bf16 v[244:247], v[88:91], v[204:207], 0
    v_add_f32_dpp v220, v220, v220 row_ror:8 row_mask:0xf bank_mask:0xf
    v_add_f32_dpp v221, v221, v221 row_ror:8 row_mask:0xf bank_mask:0xf
    v_pk_mul_f32 v[220:221], v[220:221], s[46:47]
    s_waitcnt lgkmcnt(2)
    v_mfma_f32_16x16x32_bf16 v[240:243], v[76:79], v[208:211], v[240:243]
    v_fma_f32 v220, -v221, v221, v220
    v_add_f32 v220, |v220|, s45
    v_mfma_f32_16x16x32_bf16 v[244:247], v[92:95], v[208:211], v[244:247]
    v_rsq_f32 v222, v220
    s_waitcnt lgkmcnt(1)
    v_mfma_f32_16x16x32_bf16 v[240:243], v[80:83], v[212:215], v[240:243]
    v_mul_f32 v222, 0x3e0293ee, v222
    v_mul_f32 v223, v221, v222
    v_mfma_f32_16x16x32_bf16 v[244:247], v[96:99], v[212:215], v[244:247]
    v_pk_mul_f32 v[220:221], v[196:197], v[222:223] op_sel:[0,1] op_sel_hi:[1,1]
    s_waitcnt lgkmcnt(0)
    v_mfma_f32_16x16x32_bf16 v[240:243], v[84:87], v[216:219], v[240:243]
    v_mfma_f32_16x16x32_bf16 v[244:247], v[100:103], v[216:219], v[244:247]
    s_nop 3
    v_add_f32_dpp v248, v240, v240 row_ror:8 row_mask:0xf bank_mask:0x3
    v_add_f32_dpp v249, v241, v241 row_ror:8 row_mask:0xf bank_mask:0x3
    v_add_f32_dpp v250, v242, v242 row_ror:8 row_mask:0xf bank_mask:0x3
    v_add_f32_dpp v251, v243, v243 row_ror:8 row_mask:0xf bank_mask:0x3
    v_add_f32_dpp v248, v244, v244 row_ror:8 row_mask:0xf bank_mask:0xc
    v_add_f32_dpp v249, v245, v245 row_ror:8 row_mask:0xf bank_mask:0xc
    v_add_f32_dpp v250, v246, v246 row_ror:8 row_mask:0xf bank_mask:0xc
    v_add_f32_dpp v251, v247, v247 row_ror:8 row_mask:0xf bank_mask:0xc
    v_add_f32_dpp v252, v248, v248 row_shl:4 row_mask:0xf bank_mask:0x5
    v_add_f32_dpp v253, v249, v249 row_shl:4 row_mask:0xf bank_mask:0x5
    v_add_f32_dpp v252, v250, v250 row_shr:4 row_mask:0xf bank_mask:0xa
    v_add_f32_dpp v253, v251, v251 row_shr:4 row_mask:0xf bank_mask:0xa
    v_pk_fma_f32 v[252:253], v[252:253], v[222:223], v[220:221] op_sel_hi:[1,0,1] neg_lo:[0,0,1] neg_hi:[0,0,1]
    v_exp_f32 v248, v252
    v_exp_f32 v249, v253
    v_max_f32 v254, |v252|, |v253|
    v_cvt_pk_bf16_f32 v248, v248, v249
    ds_write2st64_b32 v191, v248, v5 offset0:0 offset1:4
    v_cmp_lt_f32 vcc, s10, v254
    s_cbranch_vccnz L_sm0_maxs
L_sm0_dones:
    s_mov_b64 exec, 1
    ds_add_u32 v5, v6 offset:58248
    s_mov_b64 exec, -1
L_w14:
    ds_read_b32 v15, v5 offset:58248
    s_waitcnt lgkmcnt(0)
    v_cmp_gt_i32 vcc, 4, v15
    s_cbranch_vccnz L_w14
    s_mov_b32 s65, 0x8000
    s_mov_b32 s60, 0x1000
L_w15:
    ds_read_b32 v15, v5 offset:58240
    s_waitcnt lgkmcnt(0)
    v_cmp_gt_i32 vcc, 22, v15
    s_cbranch_vccnz L_w15
    ds_read_b64_tr_b16 v[104:105], v8 offset:0
    ds_read_b64_tr_b16 v[106:107], v8 offset:4096
    ds_read_b64_tr_b16 v[108:109], v8 offset:8
    ds_read_b64_tr_b16 v[110:111], v8 offset:4104
    ds_read_b64_tr_b16 v[112:113], v8 offset:8192
    ds_read_b64_tr_b16 v[114:115], v8 offset:12288
    ds_read_b64_tr_b16 v[116:117], v8 offset:8200
    ds_read_b64_tr_b16 v[118:119], v8 offset:12296
    ds_read_b64_tr_b16 v[120:121], v8 offset:16384
    ds_read_b64_tr_b16 v[122:123], v8 offset:20480
    ds_read_b64_tr_b16 v[124:125], v8 offset:16392
    ds_read_b64_tr_b16 v[126:127], v8 offset:20488
    ds_read_b64_tr_b16 v[128:129], v8 offset:24576
    ds_read_b64_tr_b16 v[130:131], v8 offset:28672
    ds_read_b64_tr_b16 v[132:133], v8 offset:24584
    ds_read_b64_tr_b16 v[134:135], v8 offset:28680
    ds_read_b128 v[204:207], v168
    ds_read_b32 v236, v192 offset:1024
    ds_read_b128 v[208:211], v168 offset:256
    ds_read_b128 v[212:215], v169 offset:512
    ds_read_b128 v[216:219], v169 offset:768
    ds_read_b128 v[220:223], v192
    v_mov_b32 v240, 0
    s_waitcnt lgkmcnt(5)
    v_mfma_f32_16x16x32_bf16 v[228:231], v[104:107], v[204:207], 0
    s_waitcnt lgkmcnt(3)
    v_cmp_neq_f32 vcc, 0, v236
    v_mfma_f32_16x16x32_bf16 v[232:235], v[108:111], v[204:207], 0
    v_mfma_f32_16x16x32_bf16 v[228:231], v[112:115], v[208:211], v[228:231]
    s_cbranch_vccnz L_pv0_mixs
    v_mfma_f32_16x16x32_bf16 v[232:235], v[116:119], v[208:211], v[232:235]
    s_waitcnt lgkmcnt(0)
    v_mfma_f32_16x16x32_bf16 v[228:231], v[120:123], v[212:215], v[228:231]
    v_mfma_f32_16x16x32_bf16 v[228:231], v[128:131], v[216:219], v[228:231]
    v_mfma_f32_16x16x32_bf16 v[224:227], v[156:159], v[220:223], 0
    v_mfma_f32_16x16x32_bf16 v[232:235], v[124:127], v[212:215], v[232:235]
    v_mfma_f32_16x16x32_bf16 v[232:235], v[132:135], v[216:219], v[232:235]
    v_add_f32_dpp v241, v224, v224 row_ror:4 row_mask:0xf bank_mask:0xf
    v_cvt_pk_bf16_f32 v248, v228, v229
    s_nop 0
    v_add_f32_dpp v241, v241, v241 row_ror:8 row_mask:0xf bank_mask:0xf
    buffer_store_dwordx2 v[240:241], v183, s[40:43], 0 offen offset:0 sc1
    s_mov_b64 exec, s[14:15]
    v_cvt_pk_bf16_f32 v248, v230, v231
    s_mov_b64 exec, s[16:17]
    v_cvt_pk_bf16_f32 v248, v232, v233
    s_mov_b64 exec, s[18:19]
    v_cvt_pk_bf16_f32 v248, v234, v235
    s_mov_b64 exec, -1
    buffer_store_dword v248, v182, s[40:43], 0 offen offset:0 sc1
L_pv0_dones:
L_w16:
    ds_read_b32 v15, v5 offset:58240
    s_waitcnt lgkmcnt(0)
    v_cmp_gt_i32 vcc, 27, v15
    s_cbranch_vccnz L_w16
    ds_read_b64_tr_b16 v[32:33], v201 offset:16384
    ds_read_b64_tr_b16 v[34:35], v201 offset:18432
    v_xor_b32 v15, 4096, v201
    ds_read_b64_tr_b16 v[36:37], v15 offset:16384
    ds_read_b64_tr_b16 v[38:39], v15 offset:18432
    v_xor_b32 v15, 8192, v201
    ds_read_b64_tr_b16 v[40:41], v15 offset:16384
    ds_read_b64_tr_b16 v[42:43], v15 offset:18432
    v_xor_b32 v15, 12288, v201
    ds_read_b64_tr_b16 v[44:45], v15 offset:16384
    ds_read_b64_tr_b16 v[46:47], v15 offset:18432
    s_waitcnt vmcnt(0)
L_wo0s:
    buffer_load_dwordx2 v[212:213], v185, s[40:43], 0 offen offset:0 sc1
    buffer_load_dwordx4 v[204:207], v184, s[40:43], 0 offen sc1
    buffer_load_dwordx4 v[208:211], v184, s[40:43], 0 offen offset:1024 sc1
    s_sub_u32 s59, s59, 1
    s_cbranch_scc1 L_giveup
    s_waitcnt vmcnt(2)
    v_cmp_neq_f32 vcc, 0, v212
    v_add_f32_dpp v239, v213, v213 quad_perm:[1,0,3,2] row_mask:0xf bank_mask:0xf
    s_waitcnt vmcnt(1)
    v_mfma_f32_16x16x32_bf16 v[216:219], v[136:139], v[204:207], 0
    s_cbranch_vccnz L_wo0_chks
    s_waitcnt vmcnt(0)
    v_mfma_f32_16x16x32_bf16 v[216:219], v[136:139], v[208:211], v[216:219]
    v_max_u32 v236, v204, v208
    v_cmp_eq_u32 vcc, -1, v236
    v_add_f32_dpp v239, v239, v239 quad_perm:[2,3,0,1] row_mask:0xf bank_mask:0xf
    s_nop 1
    v_add_f32_dpp v239, v239, v239 row_ror:4 row_mask:0xf bank_mask:0xf
    s_cbranch_vccnz L_wo0s
    v_add_f32_dpp v237, v216, v216 row_ror:8 row_mask:0xf bank_mask:0x3
    v_add_f32_dpp v238, v217, v217 row_ror:8 row_mask:0xf bank_mask:0x3
    v_add_f32_dpp v237, v218, v218 row_ror:8 row_mask:0xf bank_mask:0xc
    v_add_f32_dpp v238, v219, v219 row_ror:8 row_mask:0xf bank_mask:0xc
    s_nop 0
    v_add_f32_dpp v236, v237, v237 row_shl:4 row_mask:0xf bank_mask:0x5
    v_add_f32_dpp v236, v238, v238 row_shr:4 row_mask:0xf bank_mask:0xa
L_wo0_sums:
    v_cvt_pk_bf16_f32 v237, v236, v236
    ds_write_b16 v188, v237 offset:57856
    v_cmp_u_f32 vcc, v236, v239
    v_add_f32_dpp v236, v239, v239 row_ror:8 row_mask:0xf bank_mask:0xf
    s_cbranch_vccnz L_wo0s
    v_mov_b32 v239, v236
    s_waitcnt lgkmcnt(0)
    s_barrier
    ds_read_b32 v15, v5 offset:58256
    ds_read_b128 v[204:207], v190 offset:57856
    v_permlane32_swap_b32 v239, v236
    v_add_f32 v239, v239, v236
    v_rcp_f32 v239, v239
    s_waitcnt lgkmcnt(0)
    v_mfma_f32_16x16x32_bf16 v[208:211], v[204:207], v[32:35], 0
    v_mfma_f32_16x16x32_bf16 v[212:215], v[204:207], v[36:39], 0
    v_mfma_f32_16x16x32_bf16 v[216:219], v[204:207], v[40:43], 0
    v_mfma_f32_16x16x32_bf16 v[220:223], v[204:207], v[44:47], 0
    v_add_f32 v208, v208, v213
    s_nop 2
    v_add_f32 v208, v208, v218
    v_mul_f32 v208, v208, v239
    s_nop 1
    v_fmac_f32 v208, v223, v239
    v_cvt_pk_bf16_f32 v208, s5, v208
    buffer_store_dword v208, v11, s[36:39], 0 offen sc1
    v_readfirstlane_b32 s62, v15
    s_lshr_b32 s9, s52, 1
    s_lshl_b32 s9, s9, 15
    s_add_u32 s9, s9, s62
    s_xor_b32 s6, s9, 0x8000
    s_xor_b32 s7, s9, 0x10000
    s_xor_b32 s8, s9, 0x18000
    v_readfirstlane_b32 s48, v177
    s_nop 0
    s_andn2_b32 s48, s48, 0x2820
    s_mul_i32 s49, s56, s56
    s_lshl_b32 s49, s49, 16
    s_add_u32 s48, s48, s49
    s_add_u32 s48, s48, 0xc0000
    s_cmp_eq_u32 s56, 3
    s_cselect_b32 s48, 0x3ff00000, s48
    v_and_b32 v14, 15, v0
    v_lshlrev_b32 v14, 2, v14
    v_and_b32 v15, 1, v1
    v_lshl_add_u32 v14, v15, 11, v14
    v_lshrrev_b32 v15, 5, v0
    v_lshl_add_u32 v14, v15, 13, v14
    buffer_store_dword v202, v14, s[36:39], s48 offen sc1
    ds_read_b64_tr_b16 v[48:49], v201 offset:32768
    ds_read_b64_tr_b16 v[50:51], v201 offset:34816
    v_xor_b32 v15, 4096, v201
    ds_read_b64_tr_b16 v[52:53], v15 offset:32768
    ds_read_b64_tr_b16 v[54:55], v15 offset:34816
    v_xor_b32 v15, 8192, v201
    ds_read_b64_tr_b16 v[56:57], v15 offset:32768
    ds_read_b64_tr_b16 v[58:59], v15 offset:34816
    v_xor_b32 v15, 12288, v201
    ds_read_b64_tr_b16 v[60:61], v15 offset:32768
    ds_read_b64_tr_b16 v[62:63], v15 offset:34816
    v_and_b32 v15, 0xfff, v201
    ds_read_b64_tr_b16 v[64:65], v15 offset:49152
    ds_read_b64_tr_b16 v[66:67], v15 offset:51200
    ds_read_b64_tr_b16 v[68:69], v15 offset:53248
    ds_read_b64_tr_b16 v[70:71], v15 offset:55296
    s_waitcnt vmcnt(1)
L_su0s:
    buffer_load_dwordx4 v[232:235], v10, s[36:39], s6 offen sc1
    buffer_load_dwordx4 v[236:239], v10, s[36:39], s7 offen sc1
    buffer_load_dwordx4 v[240:243], v10, s[36:39], s8 offen sc1
    buffer_load_dwordx4 v[244:247], v10, s[36:39], s9 offen sc1
    s_sub_u32 s59, s59, 1
    s_cbranch_scc1 L_giveup
L_su0_ins:
    s_waitcnt vmcnt(3)
    v_mfma_f32_16x16x32_bf16 v[220:223], v[152:155], v[232:235], 0
    v_bitop3_b32 v226, v232, v233, s4 bitop3:0x7e
    v_bitop3_b32 v227, v234, v235, s4 bitop3:0x7e
    v_or3_b32 v225, v226, v227, 0
    s_waitcnt vmcnt(2)
    v_mfma_f32_16x16x32_bf16 v[220:223], v[152:155], v[236:239], v[220:223]
    v_bitop3_b32 v226, v236, v237, s4 bitop3:0x7e
    v_bitop3_b32 v227, v238, v239, s4 bitop3:0x7e
    v_or3_b32 v225, v226, v227, v225
    s_waitcnt vmcnt(1)
    v_mfma_f32_16x16x32_bf16 v[220:223], v[152:155], v[240:243], v[220:223]
    v_bitop3_b32 v226, v240, v241, s4 bitop3:0x7e
    v_bitop3_b32 v227, v242, v243, s4 bitop3:0x7e
    v_or3_b32 v225, v226, v227, v225
    s_waitcnt vmcnt(0)
    v_mfma_f32_16x16x32_bf16 v[220:223], v[152:155], v[244:247], v[220:223]
    v_bitop3_b32 v226, v244, v245, s4 bitop3:0x7e
    v_bitop3_b32 v227, v246, v247, s4 bitop3:0x7e
    v_or3_b32 v225, v226, v227, v225
    v_cmp_ne_u16 vcc, 0, v225
    s_cbranch_vccnz L_su0s
    v_add_f32_dpp v224, v220, v220 row_ror:8 row_mask:0xf bank_mask:0x3
    v_add_f32_dpp v224, v221, v221 row_ror:8 row_mask:0xf bank_mask:0xc
    v_cvt_pk_bf16_f32 v224, 0, v224
    v_add_f32 v224, v224, v195
    v_cvt_pk_bf16_f32 v224, 0, v224
    ds_write_b16_d16_hi v4, v224 offset:58880
    v_mul_f32 v228, v224, v224
    v_mov_b32 v229, v224
    s_nop 1
    v_permlane16_swap_b32 v228, v229
    v_add_f32 v228, v228, v229
    v_mov_b32 v195, v224
    s_add_u32 s62, s62, 0x80000
    v_add_f32_dpp v228, v228, v228 quad_perm:[1,0,3,2] row_mask:0xf bank_mask:0xf
    s_waitcnt lgkmcnt(0)
    s_barrier
    ds_read_b128 v[204:207], v189 offset:58880
    v_add_f32_dpp v228, v228, v228 quad_perm:[2,3,0,1] row_mask:0xf bank_mask:0xf
    s_cmp_eq_u32 s55, s56
    s_cselect_b32 s48, 0, 0x3ff00000
    v_add_f32_dpp v228, v228, v228 row_ror:4 row_mask:0xf bank_mask:0xf
    s_nop 1
    v_add_f32_dpp v228, v228, v228 row_ror:8 row_mask:0xf bank_mask:0xf
    buffer_store_dword v228, v181, s[40:43], s48 offen offset:128 sc1
    s_waitcnt lgkmcnt(0)
    v_mfma_f32_16x16x32_bf16 v[208:211], v[204:207], v[48:51], 0
    v_mfma_f32_16x16x32_bf16 v[212:215], v[204:207], v[52:55], 0
    v_mfma_f32_16x16x32_bf16 v[216:219], v[204:207], v[56:59], 0
    v_mfma_f32_16x16x32_bf16 v[220:223], v[204:207], v[60:63], 0
    v_add_f32 v208, v208, v213
    s_nop 2
    v_add_f32 v208, v208, v218
    s_nop 2
    v_add_f32 v208, v208, v223
    v_cvt_pk_bf16_f32 v208, v208, v208
    buffer_store_short v208, v186, s[40:43], 0 offen offset:0 sc1
    s_mov_b32 s63, 0x80000
    v_cmp_gt_u32 vcc, 16, v0
    v_add_u32 v186, 0x2000, v186
    s_nop 0
    v_cndmask_b32 v186, v13, v186, vcc
    ds_read_u16_d16_hi v195, v188 offset:58880
    s_cmp_eq_u32 s56, 3
    s_cbranch_scc0 L_dn0_bs
    s_sleep 2
L_dn0s:
    buffer_load_dwordx2 v[244:245], v180, s[40:43], 0 offen offset:128 sc1
    s_sub_u32 s59, s59, 1
    s_cbranch_scc1 L_giveup
    s_sleep 1
    buffer_load_dwordx4 v[240:243], v187, s[40:43], 0 offen sc1
    buffer_load_dwordx4 v[248:251], v187, s[40:43], s60 offen sc1
    s_waitcnt vmcnt(2)
    v_add_f32_dpp v212, v244, v244 quad_perm:[1,0,3,2] row_mask:0xf bank_mask:0xf
    v_add_f32_dpp v213, v245, v245 quad_perm:[1,0,3,2] row_mask:0xf bank_mask:0xf
    v_cmp_u_f32 vcc, v244, v245
    v_add_f32_dpp v212, v212, v212 quad_perm:[2,3,0,1] row_mask:0xf bank_mask:0xf
    v_add_f32_dpp v213, v213, v213 quad_perm:[2,3,0,1] row_mask:0xf bank_mask:0xf
    buffer_load_dwordx4 v[240:243], v187, s[40:43], 0 offen sc1
    buffer_load_dwordx4 v[248:251], v187, s[40:43], s60 offen sc1
    v_add_f32_dpp v212, v212, v212 row_ror:4 row_mask:0xf bank_mask:0xf
    v_add_f32_dpp v213, v213, v213 row_ror:4 row_mask:0xf bank_mask:0xf
    s_cbranch_vccnz L_dn0s
    v_add_f32_dpp v212, v212, v212 row_ror:8 row_mask:0xf bank_mask:0xf
    v_add_f32_dpp v213, v213, v213 row_ror:8 row_mask:0xf bank_mask:0xf
    v_pk_mul_f32 v[212:213], v[212:213], s[46:47]
    v_fma_f32 v212, -v213, v213, v212
    v_add_f32 v212, |v212|, s45
    v_rsq_f32 v214, v212
    s_nop 0
    v_mul_f32 v215, 0xbfb8aa3b, v214
L_dn0_ps:
    s_waitcnt vmcnt(2)
    v_dot2_f32_bf16 v198, v248, v156, 0
    v_dot2_f32_bf16 v199, v250, v156, 0
    v_dot2_f32_bf16 v198, v249, v156, v198
    v_dot2_f32_bf16 v199, v251, v156, v199
    s_nop 2
    v_pk_mul_f32 v[206:207], v[212:213], v[198:199] op_sel:[1,0] neg_lo:[1,0] neg_hi:[1,0]
    v_dot2_f32_bf16 v208, v240, v156, v206
    v_dot2_f32_bf16 v208, v241, v156, v208
    v_dot2_f32_bf16 v209, v242, v156, v207
    v_dot2_f32_bf16 v209, v243, v156, v209
    s_nop 0
    v_mul_f32 v210, v208, v215
    v_exp_f32 v210, v210
    v_cmp_u_f32 vcc, v208, v209
    v_add_f32 v210, 1.0, v210
    v_rcp_f32 v210, v210
    v_pk_mul_f32 v[208:209], v[208:209], v[214:215] op_sel_hi:[1,0]
    v_mul_f32 v208, v208, v210
    s_cbranch_vccnz L_dn0_agains
    v_mul_f32 v208, v208, v209
    v_cvt_pk_bf16_f32 v210, v208, v208
    ds_write_b16 v193, v210 offset:58368
    s_waitcnt lgkmcnt(0)
L_dn0_bs:
    s_barrier
    ds_read_b128 v[216:219], v194 offset:58368
    s_waitcnt lgkmcnt(0)
    v_mfma_f32_16x16x32_bf16 v[220:223], v[216:219], v[64:67], 0
    v_mfma_f32_16x16x32_bf16 v[224:227], v[216:219], v[68:71], 0
    s_nop 7
    v_add_f32 v220, v220, v225
    v_cvt_pk_bf16_f32 v220, v220, v220
    buffer_store_short v220, v177, s[36:39], s63 offen sc1
    buffer_store_dword v202, v182, s[40:43], 0 offen offset:0 sc1
    s_or_b32 s48, s2, s56
    s_cselect_b32 s48, 0x3ff00000, 0
    s_add_u32 s48, s48, 0x40000
    v_mov_b32 v15, s57
    buffer_store_dword v15, v5, s[36:39], s48 offen sc1
    s_waitcnt vmcnt(2)
L_sq1s:
    buffer_load_dwordx4 v[232:235], v176, s[36:39], s62 offen sc1
    buffer_load_dwordx4 v[236:239], v176, s[36:39], s62 offen offset:1024 sc1
    s_sub_u32 s59, s59, 1
    s_cbranch_scc1 L_giveup
    s_waitcnt vmcnt(1)
    v_mfma_f32_16x16x32_bf16 v[220:223], v[136:139], v[232:235], 0
    s_waitcnt vmcnt(0)
    v_mfma_f32_16x16x32_bf16 v[220:223], v[136:139], v[236:239], v[220:223]
    v_max_u32 v225, v232, v236
    v_cmp_eq_u32 vcc, -1, v225
    s_cbranch_vccnz L_sq1s
    v_add_f32_dpp v225, v220, v220 row_ror:8 row_mask:0xf bank_mask:0x3
    v_add_f32_dpp v226, v221, v221 row_ror:8 row_mask:0xf bank_mask:0x3
    v_add_f32_dpp v225, v222, v222 row_ror:8 row_mask:0xf bank_mask:0xc
    v_add_f32_dpp v226, v223, v223 row_ror:8 row_mask:0xf bank_mask:0xc
    s_nop 0
    v_add_f32_dpp v224, v225, v225 row_shl:4 row_mask:0xf bank_mask:0x5
    v_add_f32_dpp v224, v226, v226 row_shr:4 row_mask:0xf bank_mask:0xa
    v_cvt_pk_bf16_f32 v224, 0, v224
    v_add_f32 v224, v224, v195
    v_cvt_pk_bf16_f32 v224, 0, v224
    ds_write_b16_d16_hi v188, v224 offset:57344
    v_cmp_u_f32 vcc, v224, v224
    v_mul_f32 v228, v224, v224
    v_mov_b32 v229, v224
    s_nop 1
    v_permlane16_swap_b32 v228, v229
    s_cbranch_vccnz L_sq1s
    v_add_f32 v228, v228, v229
    v_mov_b32 v195, v224
    s_add_u32 s62, s62, 0x40000
    v_add_f32_dpp v228, v228, v228 quad_perm:[1,0,3,2] row_mask:0xf bank_mask:0xf
    s_waitcnt lgkmcnt(0)
    s_barrier
    ds_read_b128 v[204:207], v189 offset:57344
    v_add_f32_dpp v228, v228, v228 quad_perm:[2,3,0,1] row_mask:0xf bank_mask:0xf
    s_cmp_eq_u32 s55, s56
    s_cselect_b32 s48, 0, 0x3ff00000
    v_add_f32_dpp v228, v228, v228 row_ror:4 row_mask:0xf bank_mask:0xf
    s_nop 1
    v_add_f32_dpp v228, v228, v228 row_ror:8 row_mask:0xf bank_mask:0xf
    buffer_store_dword v228, v181, s[40:43], s48 offen offset:256 sc1
    s_waitcnt lgkmcnt(0)
    v_mfma_f32_16x16x32_bf16 v[208:211], v[204:207], v[16:19], 0
    v_mfma_f32_16x16x32_bf16 v[212:215], v[204:207], v[20:23], 0
    v_mfma_f32_16x16x32_bf16 v[216:219], v[204:207], v[24:27], 0
    v_mfma_f32_16x16x32_bf16 v[220:223], v[204:207], v[28:31], 0
    v_add_f32 v208, v208, v213
    s_nop 2
    v_add_f32 v208, v208, v218
    s_nop 2
    v_add_f32 v208, v208, v223
    v_cvt_pk_bf16_f32 v208, v208, v208
    buffer_store_short v208, v178, s[40:43], 0 offen offset:0 sc1
    s_mov_b32 s63, 0xc0000
    s_sleep 1
L_att1s:
    buffer_load_dwordx2 v[250:251], v180, s[40:43], 0 offen offset:256 sc1
    s_sub_u32 s59, s59, 1
    s_cbranch_scc1 L_giveup
    s_waitcnt vmcnt(1)
    buffer_load_dwordx4 v[204:207], v203, s[40:43], s65 offen sc1
    s_waitcnt vmcnt(1)
    v_add_f32_dpp v220, v250, v250 quad_perm:[1,0,3,2] row_mask:0xf bank_mask:0xf
    v_add_f32_dpp v221, v251, v251 quad_perm:[1,0,3,2] row_mask:0xf bank_mask:0xf
    v_cmp_u_f32 vcc, v250, v251
    v_add_f32_dpp v220, v220, v220 quad_perm:[2,3,0,1] row_mask:0xf bank_mask:0xf
    v_add_f32_dpp v221, v221, v221 quad_perm:[2,3,0,1] row_mask:0xf bank_mask:0xf
    s_nop 0
    v_add_f32_dpp v220, v220, v220 row_ror:4 row_mask:0xf bank_mask:0xf
    v_add_f32_dpp v221, v221, v221 row_ror:4 row_mask:0xf bank_mask:0xf
    s_cbranch_vccnz L_att1s
    v_add_f32_dpp v220, v220, v220 row_ror:8 row_mask:0xf bank_mask:0xf
    v_add_f32_dpp v221, v221, v221 row_ror:8 row_mask:0xf bank_mask:0xf
    v_pk_mul_f32 v[220:221], v[220:221], s[46:47]
    v_fma_f32 v220, -v221, v221, v220
    v_add_f32 v220, |v220|, s45
    v_rsq_f32 v222, v220
    s_nop 0
    v_mul_f32 v222, 0x3e0293ee, v222
    v_mul_f32 v223, v221, v222
    v_pk_mul_f32 v[220:221], v[196:197], v[222:223] op_sel:[0,1] op_sel_hi:[1,1]
L_att1_qs:
    s_waitcnt vmcnt(0)
    ds_write_b128 v164, v[204:207]
    v_dot2_f32_bf16 v248, v204, v156, 0
    v_dot2_f32_bf16 v248, v205, v156, v248
    v_dot2_f32_bf16 v248, v206, v156, v248
    v_dot2_f32_bf16 v248, v207, v156, v248
    v_mfma_f32_16x16x32_bf16 v[240:243], v[72:75], v[204:207], 0
    s_nop 1
    v_cmp_u_f32 vcc, v248, v248
    v_mfma_f32_16x16x32_bf16 v[244:247], v[88:91], v[204:207], 0
    s_cbranch_vccnz L_att1_agains
    s_waitcnt lgkmcnt(0)
    s_barrier
    ds_read_b128 v[208:211], v165
    ds_read_b128 v[212:215], v166
    ds_read_b128 v[216:219], v167
    s_waitcnt lgkmcnt(2)
    v_mfma_f32_16x16x32_bf16 v[240:243], v[76:79], v[208:211], v[240:243]
    v_mfma_f32_16x16x32_bf16 v[244:247], v[92:95], v[208:211], v[244:247]
    s_waitcnt lgkmcnt(1)
    v_mfma_f32_16x16x32_bf16 v[240:243], v[80:83], v[212:215], v[240:243]
    v_mfma_f32_16x16x32_bf16 v[244:247], v[96:99], v[212:215], v[244:247]
    s_waitcnt lgkmcnt(0)
    v_mfma_f32_16x16x32_bf16 v[240:243], v[84:87], v[216:219], v[240:243]
    v_mfma_f32_16x16x32_bf16 v[244:247], v[100:103], v[216:219], v[244:247]
    s_nop 3
    v_add_f32_dpp v248, v240, v240 row_ror:8 row_mask:0xf bank_mask:0x3
    v_add_f32_dpp v249, v241, v241 row_ror:8 row_mask:0xf bank_mask:0x3
    v_add_f32_dpp v250, v242, v242 row_ror:8 row_mask:0xf bank_mask:0x3
    v_add_f32_dpp v251, v243, v243 row_ror:8 row_mask:0xf bank_mask:0x3
    v_add_f32_dpp v248, v244, v244 row_ror:8 row_mask:0xf bank_mask:0xc
    v_add_f32_dpp v249, v245, v245 row_ror:8 row_mask:0xf bank_mask:0xc
    v_add_f32_dpp v250, v246, v246 row_ror:8 row_mask:0xf bank_mask:0xc
    v_add_f32_dpp v251, v247, v247 row_ror:8 row_mask:0xf bank_mask:0xc
    v_add_f32_dpp v252, v248, v248 row_shl:4 row_mask:0xf bank_mask:0x5
    v_add_f32_dpp v253, v249, v249 row_shl:4 row_mask:0xf bank_mask:0x5
    v_add_f32_dpp v252, v250, v250 row_shr:4 row_mask:0xf bank_mask:0xa
    v_add_f32_dpp v253, v251, v251 row_shr:4 row_mask:0xf bank_mask:0xa
    v_pk_fma_f32 v[252:253], v[252:253], v[222:223], v[220:221] op_sel_hi:[1,0,1] neg_lo:[0,0,1] neg_hi:[0,0,1]
    v_exp_f32 v248, v252
    v_exp_f32 v249, v253
    v_max_f32 v254, |v252|, |v253|
    v_cvt_pk_bf16_f32 v248, v248, v249
    ds_write2st64_b32 v191, v248, v5 offset0:0 offset1:4
    v_cmp_lt_f32 vcc, s10, v254
    s_cbranch_vccnz L_sm1_maxs
L_sm1_dones:
    s_waitcnt lgkmcnt(0)
    s_barrier
    ds_read_b128 v[204:207], v168
    ds_read_b32 v236, v192 offset:1024
    ds_read_b128 v[208:211], v168 offset:256
    ds_read_b128 v[212:215], v169 offset:512
    ds_read_b128 v[216:219], v169 offset:768
    ds_read_b128 v[220:223], v192
    v_mov_b32 v240, 0
    s_waitcnt lgkmcnt(5)
    v_mfma_f32_16x16x32_bf16 v[228:231], v[104:107], v[204:207], 0
    s_waitcnt lgkmcnt(3)
    v_cmp_neq_f32 vcc, 0, v236
    v_mfma_f32_16x16x32_bf16 v[232:235], v[108:111], v[204:207], 0
    v_mfma_f32_16x16x32_bf16 v[228:231], v[112:115], v[208:211], v[228:231]
    s_cbranch_vccnz L_pv1_mixs
    v_mfma_f32_16x16x32_bf16 v[232:235], v[116:119], v[208:211], v[232:235]
    s_waitcnt lgkmcnt(0)
    v_mfma_f32_16x16x32_bf16 v[228:231], v[120:123], v[212:215], v[228:231]
    v_mfma_f32_16x16x32_bf16 v[228:231], v[128:131], v[216:219], v[228:231]
    v_mfma_f32_16x16x32_bf16 v[224:227], v[156:159], v[220:223], 0
    v_mfma_f32_16x16x32_bf16 v[232:235], v[124:127], v[212:215], v[232:235]
    v_mfma_f32_16x16x32_bf16 v[232:235], v[132:135], v[216:219], v[232:235]
    v_add_f32_dpp v241, v224, v224 row_ror:4 row_mask:0xf bank_mask:0xf
    v_cvt_pk_bf16_f32 v248, v228, v229
    s_nop 0
    v_add_f32_dpp v241, v241, v241 row_ror:8 row_mask:0xf bank_mask:0xf
    buffer_store_dwordx2 v[240:241], v183, s[40:43], 0 offen offset:1024 sc1
    s_mov_b64 exec, s[14:15]
    v_cvt_pk_bf16_f32 v248, v230, v231
    s_mov_b64 exec, s[16:17]
    v_cvt_pk_bf16_f32 v248, v232, v233
    s_mov_b64 exec, s[18:19]
    v_cvt_pk_bf16_f32 v248, v234, v235
    s_mov_b64 exec, -1
    buffer_store_dword v248, v182, s[40:43], 0 offen offset:0 sc1
L_pv1_dones:
    s_waitcnt vmcnt(0)
L_wo1s:
    buffer_load_dwordx2 v[212:213], v185, s[40:43], 0 offen offset:1024 sc1
    buffer_load_dwordx4 v[204:207], v184, s[40:43], 0 offen sc1
    buffer_load_dwordx4 v[208:211], v184, s[40:43], 0 offen offset:1024 sc1
    s_sub_u32 s59, s59, 1
    s_cbranch_scc1 L_giveup
    s_waitcnt vmcnt(2)
    v_cmp_neq_f32 vcc, 0, v212
    v_add_f32_dpp v239, v213, v213 quad_perm:[1,0,3,2] row_mask:0xf bank_mask:0xf
    s_waitcnt vmcnt(1)
    v_mfma_f32_16x16x32_bf16 v[216:219], v[136:139], v[204:207], 0
    s_cbranch_vccnz L_wo1_chks
    s_waitcnt vmcnt(0)
    v_mfma_f32_16x16x32_bf16 v[216:219], v[136:139], v[208:211], v[216:219]
    v_max_u32 v236, v204, v208
    v_cmp_eq_u32 vcc, -1, v236
    v_add_f32_dpp v239, v239, v239 quad_perm:[2,3,0,1] row_mask:0xf bank_mask:0xf
    s_nop 1
    v_add_f32_dpp v239, v239, v239 row_ror:4 row_mask:0xf bank_mask:0xf
    s_cbranch_vccnz L_wo1s
    v_add_f32_dpp v237, v216, v216 row_ror:8 row_mask:0xf bank_mask:0x3
    v_add_f32_dpp v238, v217, v217 row_ror:8 row_mask:0xf bank_mask:0x3
    v_add_f32_dpp v237, v218, v218 row_ror:8 row_mask:0xf bank_mask:0xc
    v_add_f32_dpp v238, v219, v219 row_ror:8 row_mask:0xf bank_mask:0xc
    s_nop 0
    v_add_f32_dpp v236, v237, v237 row_shl:4 row_mask:0xf bank_mask:0x5
    v_add_f32_dpp v236, v238, v238 row_shr:4 row_mask:0xf bank_mask:0xa
L_wo1_sums:
    v_cvt_pk_bf16_f32 v237, v236, v236
    ds_write_b16 v188, v237 offset:57856
    v_cmp_u_f32 vcc, v236, v239
    v_add_f32_dpp v236, v239, v239 row_ror:8 row_mask:0xf bank_mask:0xf
    s_cbranch_vccnz L_wo1s
    v_mov_b32 v239, v236
    s_waitcnt lgkmcnt(0)
    s_barrier
    ds_read_b128 v[204:207], v190 offset:57856
    v_permlane32_swap_b32 v239, v236
    v_add_f32 v239, v239, v236
    v_rcp_f32 v239, v239
    s_waitcnt lgkmcnt(0)
    v_mfma_f32_16x16x32_bf16 v[208:211], v[204:207], v[32:35], 0
    v_mfma_f32_16x16x32_bf16 v[212:215], v[204:207], v[36:39], 0
    v_mfma_f32_16x16x32_bf16 v[216:219], v[204:207], v[40:43], 0
    v_mfma_f32_16x16x32_bf16 v[220:223], v[204:207], v[44:47], 0
    v_add_f32 v208, v208, v213
    s_nop 2
    v_add_f32 v208, v208, v218
    v_mul_f32 v208, v208, v239
    s_nop 1
    v_fmac_f32 v208, v223, v239
    v_cvt_pk_bf16_f32 v208, v208, v208
    buffer_store_short v208, v177, s[36:39], s63 offen sc1
    s_waitcnt vmcnt(0)
L_su1s:
    buffer_load_dwordx4 v[232:235], v176, s[36:39], s62 offen sc1
    buffer_load_dwordx4 v[236:239], v176, s[36:39], s62 offen offset:1024 sc1
    s_sub_u32 s59, s59, 1
    s_cbranch_scc1 L_giveup
    s_waitcnt vmcnt(1)
    v_mfma_f32_16x16x32_bf16 v[220:223], v[136:139], v[232:235], 0
    s_waitcnt vmcnt(0)
    v_mfma_f32_16x16x32_bf16 v[220:223], v[136:139], v[236:239], v[220:223]
    v_max_u32 v225, v232, v236
    v_cmp_eq_u32 vcc, -1, v225
    s_cbranch_vccnz L_su1s
    v_add_f32_dpp v225, v220, v220 row_ror:8 row_mask:0xf bank_mask:0x3
    v_add_f32_dpp v226, v221, v221 row_ror:8 row_mask:0xf bank_mask:0x3
    v_add_f32_dpp v225, v222, v222 row_ror:8 row_mask:0xf bank_mask:0xc
    v_add_f32_dpp v226, v223, v223 row_ror:8 row_mask:0xf bank_mask:0xc
    s_nop 0
    v_add_f32_dpp v224, v225, v225 row_shl:4 row_mask:0xf bank_mask:0x5
    v_add_f32_dpp v224, v226, v226 row_shr:4 row_mask:0xf bank_mask:0xa
    v_cvt_pk_bf16_f32 v224, 0, v224
    v_add_f32 v224, v224, v195
    v_cvt_pk_bf16_f32 v224, 0, v224
    ds_write_b16_d16_hi v188, v224 offset:58880
    v_cmp_u_f32 vcc, v224, v224
    v_mul_f32 v228, v224, v224
    v_mov_b32 v229, v224
    s_nop 1
    v_permlane16_swap_b32 v228, v229
    s_cbranch_vccnz L_su1s
    v_add_f32 v228, v228, v229
    v_mov_b32 v195, v224
    s_add_u32 s62, s62, 0x40000
    v_add_f32_dpp v228, v228, v228 quad_perm:[1,0,3,2] row_mask:0xf bank_mask:0xf
    s_waitcnt lgkmcnt(0)
    s_barrier
    ds_read_b128 v[204:207], v189 offset:58880
    v_add_f32_dpp v228, v228, v228 quad_perm:[2,3,0,1] row_mask:0xf bank_mask:0xf
    s_cmp_eq_u32 s55, s56
    s_cselect_b32 s48, 0, 0x3ff00000
    v_add_f32_dpp v228, v228, v228 row_ror:4 row_mask:0xf bank_mask:0xf
    s_nop 1
    v_add_f32_dpp v228, v228, v228 row_ror:8 row_mask:0xf bank_mask:0xf
    buffer_store_dword v228, v181, s[40:43], s48 offen offset:384 sc1
    s_waitcnt lgkmcnt(0)
    v_mfma_f32_16x16x32_bf16 v[208:211], v[204:207], v[48:51], 0
    v_mfma_f32_16x16x32_bf16 v[212:215], v[204:207], v[52:55], 0
    v_mfma_f32_16x16x32_bf16 v[216:219], v[204:207], v[56:59], 0
    v_mfma_f32_16x16x32_bf16 v[220:223], v[204:207], v[60:63], 0
    v_add_f32 v208, v208, v213
    s_nop 2
    v_add_f32 v208, v208, v218
    s_nop 2
    v_add_f32 v208, v208, v223
    v_cvt_pk_bf16_f32 v208, v208, v208
    buffer_store_short v208, v186, s[40:43], 0 offen offset:0 sc1
    s_mov_b32 s63, 0x100000
    v_and_b32 v14, 16, v0
    v_cmp_eq_u32 vcc, 0, v14
    s_nop 1
    v_cndmask_b32 v177, v13, v177, vcc
    s_cmp_eq_u32 s56, 3
    s_cbranch_scc0 L_dn1_bs
    s_sleep 2
L_dn1s:
    buffer_load_dwordx2 v[244:245], v180, s[40:43], 0 offen offset:384 sc1
    s_sub_u32 s59, s59, 1
    s_cbranch_scc1 L_giveup
    s_sleep 1
    buffer_load_dwordx4 v[240:243], v187, s[40:43], s64 offen sc1
    s_waitcnt vmcnt(1)
    v_add_f32_dpp v212, v244, v244 quad_perm:[1,0,3,2] row_mask:0xf bank_mask:0xf
    v_add_f32_dpp v213, v245, v245 quad_perm:[1,0,3,2] row_mask:0xf bank_mask:0xf
    v_cmp_u_f32 vcc, v244, v245
    v_add_f32_dpp v212, v212, v212 quad_perm:[2,3,0,1] row_mask:0xf bank_mask:0xf
    v_add_f32_dpp v213, v213, v213 quad_perm:[2,3,0,1] row_mask:0xf bank_mask:0xf
    buffer_load_dwordx4 v[240:243], v187, s[40:43], s64 offen sc1
    v_add_f32_dpp v212, v212, v212 row_ror:4 row_mask:0xf bank_mask:0xf
    v_add_f32_dpp v213, v213, v213 row_ror:4 row_mask:0xf bank_mask:0xf
    s_cbranch_vccnz L_dn1s
    v_add_f32_dpp v212, v212, v212 row_ror:8 row_mask:0xf bank_mask:0xf
    v_add_f32_dpp v213, v213, v213 row_ror:8 row_mask:0xf bank_mask:0xf
    v_pk_mul_f32 v[212:213], v[212:213], s[46:47]
    v_fma_f32 v212, -v213, v213, v212
    v_add_f32 v212, |v212|, s45
    v_rsq_f32 v214, v212
    v_pk_mul_f32 v[206:207], v[212:213], v[198:199] op_sel:[1,0] neg_lo:[1,0] neg_hi:[1,0]
    v_mul_f32 v215, 0xbfb8aa3b, v214
L_dn1_ps:
    s_waitcnt vmcnt(1)
    v_dot2_f32_bf16 v208, v240, v156, v206
    v_dot2_f32_bf16 v208, v241, v156, v208
    v_dot2_f32_bf16 v209, v242, v156, v207
    v_dot2_f32_bf16 v209, v243, v156, v209
    s_nop 0
    v_mul_f32 v210, v208, v215
    v_exp_f32 v210, v210
    v_cmp_u_f32 vcc, v208, v209
    v_add_f32 v210, 1.0, v210
    v_rcp_f32 v210, v210
    v_pk_mul_f32 v[208:209], v[208:209], v[214:215] op_sel_hi:[1,0]
    v_mul_f32 v208, v208, v210
    s_cbranch_vccnz L_dn1_agains
    v_mul_f32 v208, v208, v209
    v_cvt_pk_bf16_f32 v210, v208, v208
    ds_write_b16 v193, v210 offset:58368
    s_waitcnt lgkmcnt(0)
L_dn1_bs:
    s_barrier
    ds_read_b128 v[216:219], v194 offset:58368
    s_waitcnt lgkmcnt(0)
    v_mfma_f32_16x16x32_bf16 v[220:223], v[216:219], v[64:67], 0
    v_mfma_f32_16x16x32_bf16 v[224:227], v[216:219], v[68:71], 0
    s_nop 7
    v_add_f32 v220, v220, v225
    v_cvt_pk_bf16_f32 v220, v220, v220
    buffer_store_short v220, v177, s[36:39], s63 offen sc1
    s_branch L_last
L_sm0_max:
    v_max_f32 v254, v252, v253
    s_nop 1
    v_max_f32_dpp v254, v254, v254 row_ror:4 row_mask:0xf bank_mask:0xf
    s_nop 1
    v_max_f32_dpp v255, v254, v254 row_ror:8 row_mask:0xf bank_mask:0xf
    v_max_f32_dpp v254, v254, v254 row_ror:8 row_mask:0xf bank_mask:0xf
    s_nop 1
    v_permlane16_swap_b32 v254, v255
    v_max_f32 v248, v254, v255
    v_max_f32 v254, v254, v255
    s_nop 1
    v_permlane32_swap_b32 v254, v248
    v_max_f32 v254, v254, v248
    v_pk_add_f32 v[252:253], v[252:253], v[254:255] op_sel_hi:[1,0] neg_lo:[0,1] neg_hi:[0,1]
    v_exp_f32 v252, v252
    v_exp_f32 v253, v253
    s_nop 0
    v_cvt_pk_bf16_f32 v252, v252, v253
    ds_write2st64_b32 v191, v252, v254 offset0:0 offset1:4
    s_branch L_sm0_done
L_pv0_mix:
    s_waitcnt lgkmcnt(0)
    s_nop 7
    ds_read_b128 v[204:207], v160
    ds_read_b128 v[208:211], v161
    ds_read_b128 v[212:215], v162
    ds_read_b128 v[216:219], v163
    v_mfma_f32_16x16x32_bf16 v[224:227], v[156:159], v[220:223], 0
    v_max_f32_dpp v240, v236, v236 row_ror:4 row_mask:0xf bank_mask:0xf
    s_nop 1
    v_max_f32_dpp v240, v240, v240 row_ror:8 row_mask:0xf bank_mask:0xf
    v_sub_f32 v238, v236, v240
    v_exp_f32 v238, v238
    s_nop 1
    v_mul_f32 v241, v238, v224
    s_nop 1
    v_add_f32_dpp v241, v241, v241 row_ror:4 row_mask:0xf bank_mask:0xf
    s_nop 1
    v_add_f32_dpp v241, v241, v241 row_ror:8 row_mask:0xf bank_mask:0xf
    s_waitcnt lgkmcnt(0)
    v_mfma_f32_16x16x32_bf16 v[228:231], v[104:107], v[204:207], 0
    v_mfma_f32_16x16x32_bf16 v[232:235], v[108:111], v[204:207], 0
    v_mfma_f32_16x16x32_bf16 v[228:231], v[112:115], v[208:211], v[228:231]
    v_mfma_f32_16x16x32_bf16 v[232:235], v[116:119], v[208:211], v[232:235]
    v_mfma_f32_16x16x32_bf16 v[228:231], v[120:123], v[212:215], v[228:231]
    v_mfma_f32_16x16x32_bf16 v[232:235], v[124:127], v[212:215], v[232:235]
    v_mfma_f32_16x16x32_bf16 v[228:231], v[128:131], v[216:219], v[228:231]
    v_mfma_f32_16x16x32_bf16 v[232:235], v[132:135], v[216:219], v[232:235]
    s_nop 3
    v_pk_mul_f32 v[228:229], v[228:229], v[238:239] op_sel_hi:[1,0]
    v_pk_mul_f32 v[230:231], v[230:231], v[238:239] op_sel_hi:[1,0]
    s_nop 1
    v_pk_mul_f32 v[232:233], v[232:233], v[238:239] op_sel_hi:[1,0]
    v_pk_mul_f32 v[234:235], v[234:235], v[238:239] op_sel_hi:[1,0]
    v_add_f32_dpp v244, v228, v228 row_ror:8 row_mask:0xf bank_mask:0x3
    v_add_f32_dpp v245, v229, v229 row_ror:8 row_mask:0xf bank_mask:0x3
    v_add_f32_dpp v246, v230, v230 row_ror:8 row_mask:0xf bank_mask:0x3
    v_add_f32_dpp v247, v231, v231 row_ror:8 row_mask:0xf bank_mask:0x3
    v_add_f32_dpp v244, v232, v232 row_ror:8 row_mask:0xf bank_mask:0xc
    v_add_f32_dpp v245, v233, v233 row_ror:8 row_mask:0xf bank_mask:0xc
    v_add_f32_dpp v246, v234, v234 row_ror:8 row_mask:0xf bank_mask:0xc
    v_add_f32_dpp v247, v235, v235 row_ror:8 row_mask:0xf bank_mask:0xc
    v_add_f32_dpp v248, v244, v244 row_shl:4 row_mask:0xf bank_mask:0x5
    v_add_f32_dpp v249, v245, v245 row_shl:4 row_mask:0xf bank_mask:0x5
    v_add_f32_dpp v248, v246, v246 row_shr:4 row_mask:0xf bank_mask:0xa
    v_add_f32_dpp v249, v247, v247 row_shr:4 row_mask:0xf bank_mask:0xa
    v_cvt_pk_bf16_f32 v248, v248, v249
    buffer_store_dword v248, v182, s[40:43], 0 offen offset:0
    buffer_store_dwordx2 v[240:241], v183, s[40:43], 0 offen offset:0
    s_branch L_pv0_done
L_wo0_mix:
    s_waitcnt vmcnt(0)
    s_nop 7
    v_mfma_f32_16x16x32_bf16 v[216:219], v[140:143], v[204:207], 0
    v_mfma_f32_16x16x32_bf16 v[220:223], v[144:147], v[204:207], 0
    v_mfma_f32_16x16x32_bf16 v[224:227], v[140:143], v[208:211], 0
    v_mfma_f32_16x16x32_bf16 v[228:231], v[144:147], v[208:211], 0
    v_max_f32_dpp v214, v212, v212 quad_perm:[1,0,3,2] row_mask:0xf bank_mask:0xf
    s_nop 1
    v_max_f32_dpp v214, v214, v214 quad_perm:[2,3,0,1] row_mask:0xf bank_mask:0xf
    s_nop 1
    v_max_f32_dpp v214, v214, v214 row_ror:4 row_mask:0xf bank_mask:0xf
    s_nop 1
    v_max_f32_dpp v214, v214, v214 row_ror:8 row_mask:0xf bank_mask:0xf
    v_mov_b32 v215, v214
    s_nop 1
    v_permlane32_swap_b32 v214, v215
    v_max_f32 v214, v214, v215
    v_sub_f32 v215, v212, v214
    v_exp_f32 v215, v215
    s_nop 0
    v_mul_f32 v239, v215, v213
    v_mul_f32_dpp v232, v215, v216 quad_perm:[0,0,0,0] row_mask:0xf bank_mask:0xf
    v_mul_f32_dpp v233, v215, v217 quad_perm:[0,0,0,0] row_mask:0xf bank_mask:0xf
    v_mul_f32_dpp v234, v215, v218 quad_perm:[0,0,0,0] row_mask:0xf bank_mask:0xf
    v_mul_f32_dpp v235, v215, v219 quad_perm:[0,0,0,0] row_mask:0xf bank_mask:0xf
    v_fmac_f32_dpp v232, v215, v220 quad_perm:[1,1,1,1] row_mask:0xf bank_mask:0xf
    v_fmac_f32_dpp v233, v215, v221 quad_perm:[1,1,1,1] row_mask:0xf bank_mask:0xf
    v_fmac_f32_dpp v234, v215, v222 quad_perm:[1,1,1,1] row_mask:0xf bank_mask:0xf
    v_fmac_f32_dpp v235, v215, v223 quad_perm:[1,1,1,1] row_mask:0xf bank_mask:0xf
    v_fmac_f32_dpp v232, v215, v224 quad_perm:[2,2,2,2] row_mask:0xf bank_mask:0xf
    v_fmac_f32_dpp v233, v215, v225 quad_perm:[2,2,2,2] row_mask:0xf bank_mask:0xf
    v_fmac_f32_dpp v234, v215, v226 quad_perm:[2,2,2,2] row_mask:0xf bank_mask:0xf
    v_fmac_f32_dpp v235, v215, v227 quad_perm:[2,2,2,2] row_mask:0xf bank_mask:0xf
    v_fmac_f32_dpp v232, v215, v228 quad_perm:[3,3,3,3] row_mask:0xf bank_mask:0xf
    v_fmac_f32_dpp v233, v215, v229 quad_perm:[3,3,3,3] row_mask:0xf bank_mask:0xf
    v_fmac_f32_dpp v234, v215, v230 quad_perm:[3,3,3,3] row_mask:0xf bank_mask:0xf
    v_fmac_f32_dpp v235, v215, v231 quad_perm:[3,3,3,3] row_mask:0xf bank_mask:0xf
    v_add_f32_dpp v239, v239, v239 quad_perm:[1,0,3,2] row_mask:0xf bank_mask:0xf
    s_nop 1
    v_add_f32_dpp v239, v239, v239 quad_perm:[2,3,0,1] row_mask:0xf bank_mask:0xf
    s_nop 1
    v_add_f32_dpp v239, v239, v239 row_ror:4 row_mask:0xf bank_mask:0xf
    v_add_f32_dpp v237, v232, v232 row_ror:8 row_mask:0xf bank_mask:0x3
    v_add_f32_dpp v238, v233, v233 row_ror:8 row_mask:0xf bank_mask:0x3
    v_add_f32_dpp v237, v234, v234 row_ror:8 row_mask:0xf bank_mask:0xc
    v_add_f32_dpp v238, v235, v235 row_ror:8 row_mask:0xf bank_mask:0xc
    s_nop 0
    v_add_f32_dpp v236, v237, v237 row_shl:4 row_mask:0xf bank_mask:0x5
    v_add_f32_dpp v236, v238, v238 row_shr:4 row_mask:0xf bank_mask:0xa
    v_mov_b32 v237, v236
    s_nop 1
    v_permlane32_swap_b32 v236, v237
    v_add_f32 v236, v236, v237
    s_branch L_wo0_sum
L_sm1_max:
    v_max_f32 v254, v252, v253
    s_nop 1
    v_max_f32_dpp v254, v254, v254 row_ror:4 row_mask:0xf bank_mask:0xf
    s_nop 1
    v_max_f32_dpp v255, v254, v254 row_ror:8 row_mask:0xf bank_mask:0xf
    v_max_f32_dpp v254, v254, v254 row_ror:8 row_mask:0xf bank_mask:0xf
    s_nop 1
    v_permlane16_swap_b32 v254, v255
    v_max_f32 v248, v254, v255
    v_max_f32 v254, v254, v255
    s_nop 1
    v_permlane32_swap_b32 v254, v248
    v_max_f32 v254, v254, v248
    v_pk_add_f32 v[252:253], v[252:253], v[254:255] op_sel_hi:[1,0] neg_lo:[0,1] neg_hi:[0,1]
    v_exp_f32 v252, v252
    v_exp_f32 v253, v253
    s_nop 0
    v_cvt_pk_bf16_f32 v252, v252, v253
    ds_write2st64_b32 v191, v252, v254 offset0:0 offset1:4
    s_branch L_sm1_done
L_pv1_mix:
    s_waitcnt lgkmcnt(0)
    s_nop 7
    ds_read_b128 v[204:207], v160
    ds_read_b128 v[208:211], v161
    ds_read_b128 v[212:215], v162
    ds_read_b128 v[216:219], v163
    v_mfma_f32_16x16x32_bf16 v[224:227], v[156:159], v[220:223], 0
    v_max_f32_dpp v240, v236, v236 row_ror:4 row_mask:0xf bank_mask:0xf
    s_nop 1
    v_max_f32_dpp v240, v240, v240 row_ror:8 row_mask:0xf bank_mask:0xf
    v_sub_f32 v238, v236, v240
    v_exp_f32 v238, v238
    s_nop 1
    v_mul_f32 v241, v238, v224
    s_nop 1
    v_add_f32_dpp v241, v241, v241 row_ror:4 row_mask:0xf bank_mask:0xf
    s_nop 1
    v_add_f32_dpp v241, v241, v241 row_ror:8 row_mask:0xf bank_mask:0xf
    s_waitcnt lgkmcnt(0)
    v_mfma_f32_16x16x32_bf16 v[228:231], v[104:107], v[204:207], 0
    v_mfma_f32_16x16x32_bf16 v[232:235], v[108:111], v[204:207], 0
    v_mfma_f32_16x16x32_bf16 v[228:231], v[112:115], v[208:211], v[228:231]
    v_mfma_f32_16x16x32_bf16 v[232:235], v[116:119], v[208:211], v[232:235]
    v_mfma_f32_16x16x32_bf16 v[228:231], v[120:123], v[212:215], v[228:231]
    v_mfma_f32_16x16x32_bf16 v[232:235], v[124:127], v[212:215], v[232:235]
    v_mfma_f32_16x16x32_bf16 v[228:231], v[128:131], v[216:219], v[228:231]
    v_mfma_f32_16x16x32_bf16 v[232:235], v[132:135], v[216:219], v[232:235]
    s_nop 3
    v_pk_mul_f32 v[228:229], v[228:229], v[238:239] op_sel_hi:[1,0]
    v_pk_mul_f32 v[230:231], v[230:231], v[238:239] op_sel_hi:[1,0]
    s_nop 1
    v_pk_mul_f32 v[232:233], v[232:233], v[238:239] op_sel_hi:[1,0]
    v_pk_mul_f32 v[234:235], v[234:235], v[238:239] op_sel_hi:[1,0]
    v_add_f32_dpp v244, v228, v228 row_ror:8 row_mask:0xf bank_mask:0x3
    v_add_f32_dpp v245, v229, v229 row_ror:8 row_mask:0xf bank_mask:0x3
    v_add_f32_dpp v246, v230, v230 row_ror:8 row_mask:0xf bank_mask:0x3
    v_add_f32_dpp v247, v231, v231 row_ror:8 row_mask:0xf bank_mask:0x3
    v_add_f32_dpp v244, v232, v232 row_ror:8 row_mask:0xf bank_mask:0xc
    v_add_f32_dpp v245, v233, v233 row_ror:8 row_mask:0xf bank_mask:0xc
    v_add_f32_dpp v246, v234, v234 row_ror:8 row_mask:0xf bank_mask:0xc
    v_add_f32_dpp v247, v235, v235 row_ror:8 row_mask:0xf bank_mask:0xc
    v_add_f32_dpp v248, v244, v244 row_shl:4 row_mask:0xf bank_mask:0x5
    v_add_f32_dpp v249, v245, v245 row_shl:4 row_mask:0xf bank_mask:0x5
    v_add_f32_dpp v248, v246, v246 row_shr:4 row_mask:0xf bank_mask:0xa
    v_add_f32_dpp v249, v247, v247 row_shr:4 row_mask:0xf bank_mask:0xa
    v_cvt_pk_bf16_f32 v248, v248, v249
    buffer_store_dword v248, v182, s[40:43], 0 offen offset:0
    buffer_store_dwordx2 v[240:241], v183, s[40:43], 0 offen offset:1024
    s_branch L_pv1_done
L_wo1_mix:
    s_waitcnt vmcnt(0)
    s_nop 7
    v_mfma_f32_16x16x32_bf16 v[216:219], v[140:143], v[204:207], 0
    v_mfma_f32_16x16x32_bf16 v[220:223], v[144:147], v[204:207], 0
    v_mfma_f32_16x16x32_bf16 v[224:227], v[140:143], v[208:211], 0
    v_mfma_f32_16x16x32_bf16 v[228:231], v[144:147], v[208:211], 0
    v_max_f32_dpp v214, v212, v212 quad_perm:[1,0,3,2] row_mask:0xf bank_mask:0xf
    s_nop 1
    v_max_f32_dpp v214, v214, v214 quad_perm:[2,3,0,1] row_mask:0xf bank_mask:0xf
    s_nop 1
    v_max_f32_dpp v214, v214, v214 row_ror:4 row_mask:0xf bank_mask:0xf
    s_nop 1
    v_max_f32_dpp v214, v214, v214 row_ror:8 row_mask:0xf bank_mask:0xf
    v_mov_b32 v215, v214
    s_nop 1
    v_permlane32_swap_b32 v214, v215
    v_max_f32 v214, v214, v215
    v_sub_f32 v215, v212, v214
    v_exp_f32 v215, v215
    s_nop 0
    v_mul_f32 v239, v215, v213
    v_mul_f32_dpp v232, v215, v216 quad_perm:[0,0,0,0] row_mask:0xf bank_mask:0xf
    v_mul_f32_dpp v233, v215, v217 quad_perm:[0,0,0,0] row_mask:0xf bank_mask:0xf
    v_mul_f32_dpp v234, v215, v218 quad_perm:[0,0,0,0] row_mask:0xf bank_mask:0xf
    v_mul_f32_dpp v235, v215, v219 quad_perm:[0,0,0,0] row_mask:0xf bank_mask:0xf
    v_fmac_f32_dpp v232, v215, v220 quad_perm:[1,1,1,1] row_mask:0xf bank_mask:0xf
    v_fmac_f32_dpp v233, v215, v221 quad_perm:[1,1,1,1] row_mask:0xf bank_mask:0xf
    v_fmac_f32_dpp v234, v215, v222 quad_perm:[1,1,1,1] row_mask:0xf bank_mask:0xf
    v_fmac_f32_dpp v235, v215, v223 quad_perm:[1,1,1,1] row_mask:0xf bank_mask:0xf
    v_fmac_f32_dpp v232, v215, v224 quad_perm:[2,2,2,2] row_mask:0xf bank_mask:0xf
    v_fmac_f32_dpp v233, v215, v225 quad_perm:[2,2,2,2] row_mask:0xf bank_mask:0xf
    v_fmac_f32_dpp v234, v215, v226 quad_perm:[2,2,2,2] row_mask:0xf bank_mask:0xf
    v_fmac_f32_dpp v235, v215, v227 quad_perm:[2,2,2,2] row_mask:0xf bank_mask:0xf
    v_fmac_f32_dpp v232, v215, v228 quad_perm:[3,3,3,3] row_mask:0xf bank_mask:0xf
    v_fmac_f32_dpp v233, v215, v229 quad_perm:[3,3,3,3] row_mask:0xf bank_mask:0xf
    v_fmac_f32_dpp v234, v215, v230 quad_perm:[3,3,3,3] row_mask:0xf bank_mask:0xf
    v_fmac_f32_dpp v235, v215, v231 quad_perm:[3,3,3,3] row_mask:0xf bank_mask:0xf
    v_add_f32_dpp v239, v239, v239 quad_perm:[1,0,3,2] row_mask:0xf bank_mask:0xf
    s_nop 1
    v_add_f32_dpp v239, v239, v239 quad_perm:[2,3,0,1] row_mask:0xf bank_mask:0xf
    s_nop 1
    v_add_f32_dpp v239, v239, v239 row_ror:4 row_mask:0xf bank_mask:0xf
    v_add_f32_dpp v237, v232, v232 row_ror:8 row_mask:0xf bank_mask:0x3
    v_add_f32_dpp v238, v233, v233 row_ror:8 row_mask:0xf bank_mask:0x3
    v_add_f32_dpp v237, v234, v234 row_ror:8 row_mask:0xf bank_mask:0xc
    v_add_f32_dpp v238, v235, v235 row_ror:8 row_mask:0xf bank_mask:0xc
    s_nop 0
    v_add_f32_dpp v236, v237, v237 row_shl:4 row_mask:0xf bank_mask:0x5
    v_add_f32_dpp v236, v238, v238 row_shr:4 row_mask:0xf bank_mask:0xa
    v_mov_b32 v237, v236
    s_nop 1
    v_permlane32_swap_b32 v236, v237
    v_add_f32 v236, v236, v237
    s_branch L_wo1_sum
L_sm0_maxs:
    v_max_f32 v254, v252, v253
    s_nop 1
    v_max_f32_dpp v254, v254, v254 row_ror:4 row_mask:0xf bank_mask:0xf
    s_nop 1
    v_max_f32_dpp v255, v254, v254 row_ror:8 row_mask:0xf bank_mask:0xf
    v_max_f32_dpp v254, v254, v254 row_ror:8 row_mask:0xf bank_mask:0xf
    s_nop 1
    v_permlane16_swap_b32 v254, v255
    v_max_f32 v248, v254, v255
    v_max_f32 v254, v254, v255
    s_nop 1
    v_permlane32_swap_b32 v254, v248
    v_max_f32 v254, v254, v248
    v_pk_add_f32 v[252:253], v[252:253], v[254:255] op_sel_hi:[1,0] neg_lo:[0,1] neg_hi:[0,1]
    v_exp_f32 v252, v252
    v_exp_f32 v253, v253
    s_nop 0
    v_cvt_pk_bf16_f32 v252, v252, v253
    ds_write2st64_b32 v191, v252, v254 offset0:0 offset1:4
    s_branch L_sm0_dones
L_pv0_mixs:
    s_waitcnt lgkmcnt(0)
    s_nop 7
    ds_read_b128 v[204:207], v160
    ds_read_b128 v[208:211], v161
    ds_read_b128 v[212:215], v162
    ds_read_b128 v[216:219], v163
    v_mfma_f32_16x16x32_bf16 v[224:227], v[156:159], v[220:223], 0
    v_max_f32_dpp v240, v236, v236 row_ror:4 row_mask:0xf bank_mask:0xf
    s_nop 1
    v_max_f32_dpp v240, v240, v240 row_ror:8 row_mask:0xf bank_mask:0xf
    v_sub_f32 v238, v236, v240
    v_exp_f32 v238, v238
    s_nop 1
    v_mul_f32 v241, v238, v224
    s_nop 1
    v_add_f32_dpp v241, v241, v241 row_ror:4 row_mask:0xf bank_mask:0xf
    s_nop 1
    v_add_f32_dpp v241, v241, v241 row_ror:8 row_mask:0xf bank_mask:0xf
    s_waitcnt lgkmcnt(0)
    v_mfma_f32_16x16x32_bf16 v[228:231], v[104:107], v[204:207], 0
    v_mfma_f32_16x16x32_bf16 v[232:235], v[108:111], v[204:207], 0
    v_mfma_f32_16x16x32_bf16 v[228:231], v[112:115], v[208:211], v[228:231]
    v_mfma_f32_16x16x32_bf16 v[232:235], v[116:119], v[208:211], v[232:235]
    v_mfma_f32_16x16x32_bf16 v[228:231], v[120:123], v[212:215], v[228:231]
    v_mfma_f32_16x16x32_bf16 v[232:235], v[124:127], v[212:215], v[232:235]
    v_mfma_f32_16x16x32_bf16 v[228:231], v[128:131], v[216:219], v[228:231]
    v_mfma_f32_16x16x32_bf16 v[232:235], v[132:135], v[216:219], v[232:235]
    s_nop 3
    v_pk_mul_f32 v[228:229], v[228:229], v[238:239] op_sel_hi:[1,0]
    v_pk_mul_f32 v[230:231], v[230:231], v[238:239] op_sel_hi:[1,0]
    s_nop 1
    v_pk_mul_f32 v[232:233], v[232:233], v[238:239] op_sel_hi:[1,0]
    v_pk_mul_f32 v[234:235], v[234:235], v[238:239] op_sel_hi:[1,0]
    v_add_f32_dpp v244, v228, v228 row_ror:8 row_mask:0xf bank_mask:0x3
    v_add_f32_dpp v245, v229, v229 row_ror:8 row_mask:0xf bank_mask:0x3
    v_add_f32_dpp v246, v230, v230 row_ror:8 row_mask:0xf bank_mask:0x3
    v_add_f32_dpp v247, v231, v231 row_ror:8 row_mask:0xf bank_mask:0x3
    v_add_f32_dpp v244, v232, v232 row_ror:8 row_mask:0xf bank_mask:0xc
    v_add_f32_dpp v245, v233, v233 row_ror:8 row_mask:0xf bank_mask:0xc
    v_add_f32_dpp v246, v234, v234 row_ror:8 row_mask:0xf bank_mask:0xc
    v_add_f32_dpp v247, v235, v235 row_ror:8 row_mask:0xf bank_mask:0xc
    v_add_f32_dpp v248, v244, v244 row_shl:4 row_mask:0xf bank_mask:0x5
    v_add_f32_dpp v249, v245, v245 row_shl:4 row_mask:0xf bank_mask:0x5
    v_add_f32_dpp v248, v246, v246 row_shr:4 row_mask:0xf bank_mask:0xa
    v_add_f32_dpp v249, v247, v247 row_shr:4 row_mask:0xf bank_mask:0xa
    v_cvt_pk_bf16_f32 v248, v248, v249
    buffer_store_dword v248, v182, s[40:43], 0 offen offset:0 sc1
    buffer_store_dwordx2 v[240:241], v183, s[40:43], 0 offen offset:0 sc1
    s_branch L_pv0_dones
L_wo0_chks:
    v_cmp_u_f32 vcc, v212, v213
    s_cbranch_vccnz L_wo0s
    s_branch L_wo0_mixs
L_wo0_mixs:
    s_waitcnt vmcnt(0)
    s_nop 7
    v_mfma_f32_16x16x32_bf16 v[216:219], v[140:143], v[204:207], 0
    v_mfma_f32_16x16x32_bf16 v[220:223], v[144:147], v[204:207], 0
    v_mfma_f32_16x16x32_bf16 v[224:227], v[140:143], v[208:211], 0
    v_mfma_f32_16x16x32_bf16 v[228:231], v[144:147], v[208:211], 0
    v_max_f32_dpp v214, v212, v212 quad_perm:[1,0,3,2] row_mask:0xf bank_mask:0xf
    s_nop 1
    v_max_f32_dpp v214, v214, v214 quad_perm:[2,3,0,1] row_mask:0xf bank_mask:0xf
    s_nop 1
    v_max_f32_dpp v214, v214, v214 row_ror:4 row_mask:0xf bank_mask:0xf
    s_nop 1
    v_max_f32_dpp v214, v214, v214 row_ror:8 row_mask:0xf bank_mask:0xf
    v_mov_b32 v215, v214
    s_nop 1
    v_permlane32_swap_b32 v214, v215
    v_max_f32 v214, v214, v215
    v_sub_f32 v215, v212, v214
    v_exp_f32 v215, v215
    s_nop 0
    v_mul_f32 v239, v215, v213
    v_mul_f32_dpp v232, v215, v216 quad_perm:[0,0,0,0] row_mask:0xf bank_mask:0xf
    v_mul_f32_dpp v233, v215, v217 quad_perm:[0,0,0,0] row_mask:0xf bank_mask:0xf
    v_mul_f32_dpp v234, v215, v218 quad_perm:[0,0,0,0] row_mask:0xf bank_mask:0xf
    v_mul_f32_dpp v235, v215, v219 quad_perm:[0,0,0,0] row_mask:0xf bank_mask:0xf
    v_fmac_f32_dpp v232, v215, v220 quad_perm:[1,1,1,1] row_mask:0xf bank_mask:0xf
    v_fmac_f32_dpp v233, v215, v221 quad_perm:[1,1,1,1] row_mask:0xf bank_mask:0xf
    v_fmac_f32_dpp v234, v215, v222 quad_perm:[1,1,1,1] row_mask:0xf bank_mask:0xf
    v_fmac_f32_dpp v235, v215, v223 quad_perm:[1,1,1,1] row_mask:0xf bank_mask:0xf
    v_fmac_f32_dpp v232, v215, v224 quad_perm:[2,2,2,2] row_mask:0xf bank_mask:0xf
    v_fmac_f32_dpp v233, v215, v225 quad_perm:[2,2,2,2] row_mask:0xf bank_mask:0xf
    v_fmac_f32_dpp v234, v215, v226 quad_perm:[2,2,2,2] row_mask:0xf bank_mask:0xf
    v_fmac_f32_dpp v235, v215, v227 quad_perm:[2,2,2,2] row_mask:0xf bank_mask:0xf
    v_fmac_f32_dpp v232, v215, v228 quad_perm:[3,3,3,3] row_mask:0xf bank_mask:0xf
    v_fmac_f32_dpp v233, v215, v229 quad_perm:[3,3,3,3] row_mask:0xf bank_mask:0xf
    v_fmac_f32_dpp v234, v215, v230 quad_perm:[3,3,3,3] row_mask:0xf bank_mask:0xf
    v_fmac_f32_dpp v235, v215, v231 quad_perm:[3,3,3,3] row_mask:0xf bank_mask:0xf
    v_add_f32_dpp v239, v239, v239 quad_perm:[1,0,3,2] row_mask:0xf bank_mask:0xf
    s_nop 1
    v_add_f32_dpp v239, v239, v239 quad_perm:[2,3,0,1] row_mask:0xf bank_mask:0xf
    s_nop 1
    v_add_f32_dpp v239, v239, v239 row_ror:4 row_mask:0xf bank_mask:0xf
    v_add_f32_dpp v237, v232, v232 row_ror:8 row_mask:0xf bank_mask:0x3
    v_add_f32_dpp v238, v233, v233 row_ror:8 row_mask:0xf bank_mask:0x3
    v_add_f32_dpp v237, v234, v234 row_ror:8 row_mask:0xf bank_mask:0xc
    v_add_f32_dpp v238, v235, v235 row_ror:8 row_mask:0xf bank_mask:0xc
    s_nop 0
    v_add_f32_dpp v236, v237, v237 row_shl:4 row_mask:0xf bank_mask:0x5
    v_add_f32_dpp v236, v238, v238 row_shr:4 row_mask:0xf bank_mask:0xa
    v_mov_b32 v237, v236
    s_nop 1
    v_permlane32_swap_b32 v236, v237
    v_add_f32 v236, v236, v237
    s_branch L_wo0_sums
L_dn0_agains:
    buffer_load_dwordx4 v[240:243], v187, s[40:43], 0 offen sc1
    buffer_load_dwordx4 v[248:251], v187, s[40:43], s60 offen sc1
    s_sub_u32 s59, s59, 1
    s_cbranch_scc1 L_giveup
    s_branch L_dn0_ps
L_att1_agains:
    buffer_load_dwordx4 v[204:207], v203, s[40:43], s65 offen sc1
    s_sub_u32 s59, s59, 1
    s_cbranch_scc1 L_giveup
    s_branch L_att1_qs
L_sm1_maxs:
    v_max_f32 v254, v252, v253
    s_nop 1
    v_max_f32_dpp v254, v254, v254 row_ror:4 row_mask:0xf bank_mask:0xf
    s_nop 1
    v_max_f32_dpp v255, v254, v254 row_ror:8 row_mask:0xf bank_mask:0xf
    v_max_f32_dpp v254, v254, v254 row_ror:8 row_mask:0xf bank_mask:0xf
    s_nop 1
    v_permlane16_swap_b32 v254, v255
    v_max_f32 v248, v254, v255
    v_max_f32 v254, v254, v255
    s_nop 1
    v_permlane32_swap_b32 v254, v248
    v_max_f32 v254, v254, v248
    v_pk_add_f32 v[252:253], v[252:253], v[254:255] op_sel_hi:[1,0] neg_lo:[0,1] neg_hi:[0,1]
    v_exp_f32 v252, v252
    v_exp_f32 v253, v253
    s_nop 0
    v_cvt_pk_bf16_f32 v252, v252, v253
    ds_write2st64_b32 v191, v252, v254 offset0:0 offset1:4
    s_branch L_sm1_dones
L_pv1_mixs:
    s_waitcnt lgkmcnt(0)
    s_nop 7
    ds_read_b128 v[204:207], v160
    ds_read_b128 v[208:211], v161
    ds_read_b128 v[212:215], v162
    ds_read_b128 v[216:219], v163
    v_mfma_f32_16x16x32_bf16 v[224:227], v[156:159], v[220:223], 0
    v_max_f32_dpp v240, v236, v236 row_ror:4 row_mask:0xf bank_mask:0xf
    s_nop 1
    v_max_f32_dpp v240, v240, v240 row_ror:8 row_mask:0xf bank_mask:0xf
    v_sub_f32 v238, v236, v240
    v_exp_f32 v238, v238
    s_nop 1
    v_mul_f32 v241, v238, v224
    s_nop 1
    v_add_f32_dpp v241, v241, v241 row_ror:4 row_mask:0xf bank_mask:0xf
    s_nop 1
    v_add_f32_dpp v241, v241, v241 row_ror:8 row_mask:0xf bank_mask:0xf
    s_waitcnt lgkmcnt(0)
    v_mfma_f32_16x16x32_bf16 v[228:231], v[104:107], v[204:207], 0
    v_mfma_f32_16x16x32_bf16 v[232:235], v[108:111], v[204:207], 0
    v_mfma_f32_16x16x32_bf16 v[228:231], v[112:115], v[208:211], v[228:231]
    v_mfma_f32_16x16x32_bf16 v[232:235], v[116:119], v[208:211], v[232:235]
    v_mfma_f32_16x16x32_bf16 v[228:231], v[120:123], v[212:215], v[228:231]
    v_mfma_f32_16x16x32_bf16 v[232:235], v[124:127], v[212:215], v[232:235]
    v_mfma_f32_16x16x32_bf16 v[228:231], v[128:131], v[216:219], v[228:231]
    v_mfma_f32_16x16x32_bf16 v[232:235], v[132:135], v[216:219], v[232:235]
    s_nop 3
    v_pk_mul_f32 v[228:229], v[228:229], v[238:239] op_sel_hi:[1,0]
    v_pk_mul_f32 v[230:231], v[230:231], v[238:239] op_sel_hi:[1,0]
    s_nop 1
    v_pk_mul_f32 v[232:233], v[232:233], v[238:239] op_sel_hi:[1,0]
    v_pk_mul_f32 v[234:235], v[234:235], v[238:239] op_sel_hi:[1,0]
    v_add_f32_dpp v244, v228, v228 row_ror:8 row_mask:0xf bank_mask:0x3
    v_add_f32_dpp v245, v229, v229 row_ror:8 row_mask:0xf bank_mask:0x3
    v_add_f32_dpp v246, v230, v230 row_ror:8 row_mask:0xf bank_mask:0x3
    v_add_f32_dpp v247, v231, v231 row_ror:8 row_mask:0xf bank_mask:0x3
    v_add_f32_dpp v244, v232, v232 row_ror:8 row_mask:0xf bank_mask:0xc
    v_add_f32_dpp v245, v233, v233 row_ror:8 row_mask:0xf bank_mask:0xc
    v_add_f32_dpp v246, v234, v234 row_ror:8 row_mask:0xf bank_mask:0xc
    v_add_f32_dpp v247, v235, v235 row_ror:8 row_mask:0xf bank_mask:0xc
    v_add_f32_dpp v248, v244, v244 row_shl:4 row_mask:0xf bank_mask:0x5
    v_add_f32_dpp v249, v245, v245 row_shl:4 row_mask:0xf bank_mask:0x5
    v_add_f32_dpp v248, v246, v246 row_shr:4 row_mask:0xf bank_mask:0xa
    v_add_f32_dpp v249, v247, v247 row_shr:4 row_mask:0xf bank_mask:0xa
    v_cvt_pk_bf16_f32 v248, v248, v249
    buffer_store_dword v248, v182, s[40:43], 0 offen offset:0 sc1
    buffer_store_dwordx2 v[240:241], v183, s[40:43], 0 offen offset:1024 sc1
    s_branch L_pv1_dones
L_wo1_chks:
    v_cmp_u_f32 vcc, v212, v213
    s_cbranch_vccnz L_wo1s
    s_branch L_wo1_mixs
L_wo1_mixs:
    s_waitcnt vmcnt(0)
    s_nop 7
    v_mfma_f32_16x16x32_bf16 v[216:219], v[140:143], v[204:207], 0
    v_mfma_f32_16x16x32_bf16 v[220:223], v[144:147], v[204:207], 0
    v_mfma_f32_16x16x32_bf16 v[224:227], v[140:143], v[208:211], 0
    v_mfma_f32_16x16x32_bf16 v[228:231], v[144:147], v[208:211], 0
    v_max_f32_dpp v214, v212, v212 quad_perm:[1,0,3,2] row_mask:0xf bank_mask:0xf
    s_nop 1
    v_max_f32_dpp v214, v214, v214 quad_perm:[2,3,0,1] row_mask:0xf bank_mask:0xf
    s_nop 1
    v_max_f32_dpp v214, v214, v214 row_ror:4 row_mask:0xf bank_mask:0xf
    s_nop 1
    v_max_f32_dpp v214, v214, v214 row_ror:8 row_mask:0xf bank_mask:0xf
    v_mov_b32 v215, v214
    s_nop 1
    v_permlane32_swap_b32 v214, v215
    v_max_f32 v214, v214, v215
    v_sub_f32 v215, v212, v214
    v_exp_f32 v215, v215
    s_nop 0
    v_mul_f32 v239, v215, v213
    v_mul_f32_dpp v232, v215, v216 quad_perm:[0,0,0,0] row_mask:0xf bank_mask:0xf
    v_mul_f32_dpp v233, v215, v217 quad_perm:[0,0,0,0] row_mask:0xf bank_mask:0xf
    v_mul_f32_dpp v234, v215, v218 quad_perm:[0,0,0,0] row_mask:0xf bank_mask:0xf
    v_mul_f32_dpp v235, v215, v219 quad_perm:[0,0,0,0] row_mask:0xf bank_mask:0xf
    v_fmac_f32_dpp v232, v215, v220 quad_perm:[1,1,1,1] row_mask:0xf bank_mask:0xf
    v_fmac_f32_dpp v233, v215, v221 quad_perm:[1,1,1,1] row_mask:0xf bank_mask:0xf
    v_fmac_f32_dpp v234, v215, v222 quad_perm:[1,1,1,1] row_mask:0xf bank_mask:0xf
    v_fmac_f32_dpp v235, v215, v223 quad_perm:[1,1,1,1] row_mask:0xf bank_mask:0xf
    v_fmac_f32_dpp v232, v215, v224 quad_perm:[2,2,2,2] row_mask:0xf bank_mask:0xf
    v_fmac_f32_dpp v233, v215, v225 quad_perm:[2,2,2,2] row_mask:0xf bank_mask:0xf
    v_fmac_f32_dpp v234, v215, v226 quad_perm:[2,2,2,2] row_mask:0xf bank_mask:0xf
    v_fmac_f32_dpp v235, v215, v227 quad_perm:[2,2,2,2] row_mask:0xf bank_mask:0xf
    v_fmac_f32_dpp v232, v215, v228 quad_perm:[3,3,3,3] row_mask:0xf bank_mask:0xf
    v_fmac_f32_dpp v233, v215, v229 quad_perm:[3,3,3,3] row_mask:0xf bank_mask:0xf
    v_fmac_f32_dpp v234, v215, v230 quad_perm:[3,3,3,3] row_mask:0xf bank_mask:0xf
    v_fmac_f32_dpp v235, v215, v231 quad_perm:[3,3,3,3] row_mask:0xf bank_mask:0xf
    v_add_f32_dpp v239, v239, v239 quad_perm:[1,0,3,2] row_mask:0xf bank_mask:0xf
    s_nop 1
    v_add_f32_dpp v239, v239, v239 quad_perm:[2,3,0,1] row_mask:0xf bank_mask:0xf
    s_nop 1
    v_add_f32_dpp v239, v239, v239 row_ror:4 row_mask:0xf bank_mask:0xf
    v_add_f32_dpp v237, v232, v232 row_ror:8 row_mask:0xf bank_mask:0x3
    v_add_f32_dpp v238, v233, v233 row_ror:8 row_mask:0xf bank_mask:0x3
    v_add_f32_dpp v237, v234, v234 row_ror:8 row_mask:0xf bank_mask:0xc
    v_add_f32_dpp v238, v235, v235 row_ror:8 row_mask:0xf bank_mask:0xc
    s_nop 0
    v_add_f32_dpp v236, v237, v237 row_shl:4 row_mask:0xf bank_mask:0x5
    v_add_f32_dpp v236, v238, v238 row_shr:4 row_mask:0xf bank_mask:0xa
    v_mov_b32 v237, v236
    s_nop 1
    v_permlane32_swap_b32 v236, v237
    v_add_f32 v236, v236, v237
    s_branch L_wo1_sums
L_dn1_agains:
    buffer_load_dwordx4 v[240:243], v187, s[40:43], s64 offen sc1
    s_sub_u32 s59, s59, 1
    s_cbranch_scc1 L_giveup
    s_branch L_dn1_ps
.section .rodata,"a"
.p2align 6
.amdhsa_kernel interleave_layers__sliding_block_cached__glu_gated_swiglu__decode_kernel
  .amdhsa_next_free_vgpr 256
  .amdhsa_next_free_sgpr 102
  .amdhsa_accum_offset 256
  .amdhsa_group_segment_fixed_size 0
  .amdhsa_kernarg_size 96
  .amdhsa_user_sgpr_count 2
  .amdhsa_user_sgpr_kernarg_segment_ptr 1
  .amdhsa_system_sgpr_workgroup_id_x 1
  .amdhsa_float_denorm_mode_32 3
.end_amdhsa_kernel
```
